```python
import torch

def _softmax(x, axis=-1):
    return torch.softmax(x, dim=axis)
def _gelu(x):
    return torch.nn.functional.gelu(x, approximate="tanh")
def _silu(x):
    return torch.nn.functional.silu(x)
def _sigmoid(x):
    return torch.sigmoid(x)
def _layernorm(x, axis=-1, eps=1e-5):
    m = x.mean(dim=axis, keepdim=True)
    v = x.var(dim=axis, keepdim=True, unbiased=False)
    return (x - m) / torch.sqrt(v + eps)
def _scatter_add(tgt, idx, src, axis=0):
    return tgt.clone().index_add_(axis, idx, src)
def _segment_sum(src, seg, n):
    out = torch.zeros((n,) + src.shape[1:], dtype=src.dtype)
    return out.index_add_(0, seg, src)
def _pad(x, pw):
    flat = tuple(v for pair in reversed(pw) for v in pair)
    return torch.nn.functional.pad(x, flat)

kernel_name = 'interleave_layers__sliding_local_dilated__moe_arch_mod__prompt'

def setup_inputs():

    _w = (lambda a: (lambda t: t.to(torch.bfloat16) if t.is_floating_point() else t)(torch.as_tensor(a)))
    def _A_setup():
        B, S, D = 1, 2048, 512
        return {
            "x": _w((lambda *s: torch.randn(*s, dtype=torch.bfloat16) * 0.05)(B, S, D)),
            "wqkv": _w((lambda *s: torch.randn(*s, dtype=torch.bfloat16) * 0.05)(D, 3 * D)),
            "wo": _w((lambda *s: torch.randn(*s, dtype=torch.bfloat16) * 0.05)(D, D)),
        }
    _A_in = _A_setup()

    def _B_setup():
        B, S, D, F, C = 1, 2048, 512, 1792, 2
        return {
            "x": _w((lambda *s: torch.randn(*s, dtype=torch.bfloat16) * 0.05)(B, S, D)),
            "w_r": _w((lambda *s: torch.randn(*s, dtype=torch.bfloat16) * 0.05)(D)),
            "w_gate": _w((lambda *s: torch.randn(*s, dtype=torch.bfloat16) * 0.05)(D, F)),
            "w_up": _w((lambda *s: torch.randn(*s, dtype=torch.bfloat16) * 0.05)(D, F)),
            "w_down": _w((lambda *s: torch.randn(*s, dtype=torch.bfloat16) * 0.05)(F, D)),
        }
    _B_in = _B_setup()

    return {
        "A_x": _A_in["x"],
        "A_wqkv": _A_in["wqkv"],
        "A_wo": _A_in["wo"],
        "B_x": _B_in["x"],
        "B_w_r": _B_in["w_r"],
        "B_w_gate": _B_in["w_gate"],
        "B_w_up": _B_in["w_up"],
        "B_w_down": _B_in["w_down"],
    }

def reference(A_x, A_wqkv, A_wo, B_x, B_w_r, B_w_gate, B_w_up, B_w_down):
    def _A_ref(x, wqkv, wo):
        B, S, D = x.shape
        H = 32; Dh = D // H
        W, dil = 8, 2
        qkv = (lambda x, *d: x.permute(*d))((x @ wqkv).reshape(B, S, 3, H, Dh), 2, 0, 3, 1, 4)
        q, k, v = qkv[0], qkv[1], qkv[2]
        scale = Dh ** -0.5
        pos = torch.arange(S)
        off = torch.arange(W) * dil
        idx = pos[:, None] - off[None, :]
        mask = idx >= 0
        idx_c = torch.where(mask, idx, 0).reshape(-1)
        kg = k[:, :, idx_c, :].reshape(B, H, S, W, Dh)
        vg = v[:, :, idx_c, :].reshape(B, H, S, W, Dh)
        logits = torch.einsum("bhsd,bhswd->bhsw", q, kg) * scale
        logits = torch.where(mask[None, None, :, :], logits, -1e9)
        attn = _softmax(logits, axis=-1)
        o = torch.einsum("bhsw,bhswd->bhsd", attn, vg)
        return (lambda x, *d: x.permute(*d))(o, 0, 2, 1, 3).reshape(B, S, D) @ wo

    def _B_ref(x, w_r, w_gate, w_up, w_down):
        B, S, D = x.shape
        C = 2
        r = x @ w_r
        idx = torch.argsort(-r, axis=-1)[:, :C]
        idx_e = (lambda x, n, axis: torch.repeat_interleave(x, n, dim=axis))(idx.reshape(B, C, 1), D, axis=2)
        x_sel = (lambda x, i, axis: torch.take_along_dim(x, i, dim=axis))(x, idx_e, axis=1)
        g = _silu(x_sel @ w_gate)
        u = x_sel @ w_up
        y = (g * u) @ w_down
        r_sel = _sigmoid((lambda x, i, axis: torch.take_along_dim(x, i, dim=axis))(r, idx, axis=1))
        y = y * r_sel.reshape(B, C, 1)
        b_off = (torch.arange(B) * S).reshape(B, 1)
        flat_idx = (idx + b_off).reshape(B * C)
        zero = (x * 0.0).reshape(B * S, D)
        upd = _scatter_add(zero, flat_idx, y.reshape(B * C, D), axis=0)
        return x + upd.reshape(B, S, D)

    x = A_x
    x = x + _A_ref(_layernorm(x, axis=-1), A_wqkv, A_wo)
    x = x + _B_ref(_layernorm(x, axis=-1), B_w_r, B_w_gate, B_w_up, B_w_down)
    x = x + _A_ref(_layernorm(x, axis=-1), A_wqkv, A_wo)
    x = x + _B_ref(_layernorm(x, axis=-1), B_w_r, B_w_gate, B_w_up, B_w_down)
    return x
```

```asm
; @launch grid=(256,1,1) block=(256,1,1) lds=163840
.amdgcn_target "amdgcn-amd-amdhsa--gfx950"
.text
.globl interleave_layers__sliding_local_dilated__moe_arch_mod__prompt_kernel
.p2align 8
.type interleave_layers__sliding_local_dilated__moe_arch_mod__prompt_kernel,@function
interleave_layers__sliding_local_dilated__moe_arch_mod__prompt_kernel:
    s_cmp_ge_u32 s2, 256
    s_cbranch_scc1 L_END
    s_load_dwordx2 s[8:9], s[0:1], 0
    s_load_dwordx2 s[12:13], s[0:1], 8
    s_load_dwordx2 s[20:21], s[0:1], 80
    s_load_dwordx2 s[16:17], s[0:1], 16
    s_load_dwordx2 s[40:41], s[0:1], 32
    s_load_dwordx2 s[28:29], s[0:1], 40
    s_load_dwordx2 s[32:33], s[0:1], 48
    s_load_dwordx2 s[36:37], s[0:1], 56
    s_load_dwordx2 s[24:25], s[0:1], 64
    v_lshrrev_b32 v5, 6, v0
    v_and_b32 v0, 63, v0
    s_and_b32 s46, s2, 7
    v_readfirstlane_b32 s44, v5
    s_lshr_b32 s56, s2, 3
    s_lshr_b32 s81, s56, 3
    s_and_b32 s45, s56, 7
    s_and_b32 s82, s46, 1
    s_lshr_b32 s57, s46, 1
    s_lshl_b32 s57, s57, 2
    s_add_u32 s47, s57, s81
    s_lshr_b32 s50, s46, 0
    s_mul_i32 s50, s50, 0
    s_mul_i32 s57, s81, 0
    s_add_u32 s50, s50, s57
    s_and_b32 s50, s50, 7
    s_mov_b32 s10, 2097152
    s_mov_b32 s11, 0x20000
    s_mov_b32 s14, 1572864
    s_mov_b32 s15, 0x20000
    v_lshrrev_b32 v5, 3, v0
    v_and_b32 v6, 7, v0
    v_and_b32 v7, 6, v5
    v_xor_b32 v7, v6, v7
    v_lshlrev_b32 v7, 4, v7
    v_lshl_add_u32 v4, v5, 11, v7
    s_and_b32 s58, s44, 1
    s_lshl_b32 s58, s58, 2
    v_and_b32 v7, 2, v5
    v_or_b32 v7, s58, v7
    v_xor_b32 v7, v6, v7
    v_lshlrev_b32 v7, 4, v7
    s_lshl_b32 s59, s45, 7
    v_add_u32 v7, s59, v7
    s_lshl_b32 s60, s44, 3
    v_add_u32 v5, s60, v5
    v_mul_u32_u24 v30, 3072, v5
    v_add_u32 v30, v30, v7
    v_lshl_add_u32 v31, v5, 10, v7
    s_lshl_b32 s56, s47, 7
    s_lshl_b32 s57, s44, 5
    s_add_u32 s57, s57, s56
    s_add_u32 s57, s57, s82
    s_lshl_b32 s72, s57, 10
    s_add_u32 s57, s44, 1
    s_lshl_b32 s74, s57, 11
    s_mul_i32 s75, s44, 3072
    s_sub_u32 s56, s56, 16
    s_max_i32 s56, s56, 0
    s_add_u32 s56, s56, s82
    s_lshl_b32 s76, s56, 10
    s_lshl_b32 s73, s50, 7
    s_waitcnt lgkmcnt(0)
    s_load_dword s87, s[20:21], 0
    s_load_dword s83, s[20:21], 4
    s_lshl_b32 s56, s47, 3
    s_add_u32 s56, s56, s45
    s_lshl_b32 s56, s56, 2
    s_add_u32 s56, s56, s44
    s_lshl_b32 s56, s56, 2
    s_add_u32 s56, s56, s82
    s_lshl_b32 s56, s56, 10
    v_lshlrev_b32 v3, 4, v0
    buffer_load_dwordx4 v[96:99], v3, s[8:11], s56 offen
    buffer_load_dwordx4 v[100:103], v3, s[8:11], s56 offen offset:2048
    s_add_u32 m0, s74, 0
    s_add_u32 s78, s72, s73
    buffer_load_dwordx4 v4, s[8:11], s78 offen lds
    s_add_u32 m0, s74, 1024
    s_add_u32 s78, s78, 16384
    buffer_load_dwordx4 v4, s[8:11], s78 offen lds
    s_add_u32 m0, s75, 106496
    s_mul_i32 s79, s73, 1536
    buffer_load_dwordx4 v30, s[12:15], s79 offen lds
    buffer_load_dwordx4 v30, s[12:15], s79 offen offset:1024 lds
    s_add_u32 s73, s73, 128
    buffer_load_dwordx4 v30, s[12:15], s79 offen offset:2048 lds
    s_and_b32 s73, s73, 1023
    s_lshl_b32 s78, s44, 1
    s_add_u32 s78, s78, 0
    s_mul_i32 s79, s78, 10240
    s_add_u32 m0, s79, 1024
    s_add_u32 s78, s78, s50
    s_and_b32 s78, s78, 7
    s_lshl_b32 s78, s78, 7
    s_add_u32 s78, s78, s76
    buffer_load_dwordx4 v4, s[8:11], s78 offen lds
    s_lshl_b32 s78, s44, 1
    s_add_u32 s78, s78, 1
    s_mul_i32 s79, s78, 10240
    s_add_u32 m0, s79, 1024
    s_add_u32 s78, s78, s50
    s_and_b32 s78, s78, 7
    s_lshl_b32 s78, s78, 7
    s_add_u32 s78, s78, s76
    buffer_load_dwordx4 v4, s[8:11], s78 offen lds
    s_mov_b32 s61, m0
    s_mov_b32 m0, 162816
    s_and_b32 s56, s45, 3
    s_cmp_eq_u32 s56, 3
    s_cbranch_scc1 LA_1
    s_cmp_lt_u32 s44, 2
    s_cbranch_scc1 LA_1
    s_lshr_b32 s56, s45, 2
    s_sub_u32 s56, s45, s56
    s_mul_i32 s57, s81, 6
    s_add_u32 s56, s56, s57
    s_lshl_b32 s57, s56, 16
    v_lshlrev_b32 v17, 10, v0
    s_cmp_eq_u32 s44, 2
    s_cbranch_scc1 LA_2
    buffer_load_dword v17, s[12:15], s57 offen offset:384 lds
    s_branch LA_1
LA_2:
    s_mov_b32 s18, 524288
    s_mov_b32 s19, 0x20000
    buffer_load_dword v17, s[16:19], s57 offen offset:384 lds
LA_1:
    s_lshr_b32 s56, s2, 3
    s_cmp_lg_u32 s56, 7
    s_cbranch_scc1 LA_3
    s_getpc_b64 s[58:59]
    v_lshlrev_b32 v17, 7, v0
    s_lshl_b32 s56, s44, 13
    v_add_u32 v17, s56, v17
    v_min_u32 v17, (L_CODE_END - L_PC - 64), v17
L_PC:
    global_load_lds_dword v17, s[58:59]
LA_3:
    s_mov_b32 m0, s61
    s_mov_b32 s22, 4718592
    s_mov_b32 s23, 0x20000
    s_mov_b32 s18, 524288
    s_mov_b32 s19, 0x20000
    s_mov_b32 s42, 1024
    s_mov_b32 s43, 0x20000
    s_mov_b32 s30, 1835008
    s_mov_b32 s31, 0x20000
    s_mov_b32 s34, 1835008
    s_mov_b32 s35, 0x20000
    s_mov_b32 s38, 1835008
    s_mov_b32 s39, 0x20000
    s_mov_b32 s26, 2097152
    s_mov_b32 s27, 0x20000
    s_add_u32 m0, s75, 118784
    s_mul_i32 s79, s50, 196608
    s_add_u32 s79, s79, 98304
    buffer_load_dwordx4 v30, s[12:15], s79 offen lds
    v_and_b32 v1, 15, v0
    v_lshrrev_b32 v2, 4, v0
    v_lshlrev_b32 v3, 4, v0
    s_lshl_b32 s57, s82, 4
    s_add_u32 s48, s57, s47
    s_mov_b32 s53, 0
    s_lshl_b32 s77, s44, 10
    v_lshrrev_b32 v16, 3, v1
    v_and_b32 v17, 7, v1
    v_lshlrev_b32 v17, 7, v17
    v_lshl_add_u32 v16, v16, 10, v17
    v_and_b32 v17, 6, v1
    v_xor_b32 v18, v2, v17
    v_lshl_add_u32 v5, v18, 4, v16
    buffer_load_dwordx4 v30, s[12:15], s79 offen offset:1024 lds
    v_xor_b32 v6, 64, v5
    v_add_u32 v7, 40960, v5
    v_add_u32 v8, 40960, v6
    v_lshrrev_b32 v18, 1, v2
    v_xor_b32 v17, v17, v18
    v_lshl_add_u32 v16, v17, 4, v16
    v_and_b32 v17, 1, v2
    v_lshl_add_u32 v16, v17, 3, v16
    s_sub_u32 s56, s45, s50
    s_and_b32 s56, s56, 7
    s_mul_i32 s56, s56, 10240
    s_add_u32 s56, s56, s74
    v_add_u32 v29, s56, v16
    v_bfe_u32 v16, v0, 2, 2
    buffer_load_dwordx4 v30, s[12:15], s79 offen offset:2048 lds
    v_and_b32 v17, 2, v16
    v_and_b32 v18, 1, v2
    v_lshl_or_b32 v17, v18, 2, v17
    v_bfe_u32 v18, v0, 1, 1
    v_xor_b32 v17, v17, v18
    v_lshlrev_b32 v17, 4, v17
    v_lshl_add_u32 v17, v16, 7, v17
    v_and_b32 v18, 1, v0
    v_lshl_add_u32 v17, v18, 3, v17
    v_lshl_add_u32 v9, v2, 10, v17
    v_add_u32 v9, 81920, v9
    v_xor_b32 v10, 32, v9
    v_xor_b32 v11, 64, v9
    v_xor_b32 v12, 96, v9
    s_add_u32 m0, s74, 10240
    s_add_u32 s78, s72, s73
    buffer_load_dwordx4 v4, s[8:11], s78 offen lds
    s_lshl_b32 s56, s44, 5
    v_xor_b32 v17, s56, v17
    v_mul_u32_u24 v18, 3072, v2
    v_add_u32 v15, v17, v18
    v_add_u32 v15, 81920, v15
    v_lshlrev_b32 v13, 2, v1
    v_add_u32 v13, 156672, v13
    v_lshlrev_b32 v14, 4, v2
    v_add_u32 v14, 156672, v14
    v_and_b32 v88, 1, v2
    v_lshlrev_b32 v88, 14, v88
    v_lshrrev_b32 v89, 1, v2
    v_lshl_add_u32 v88, v89, 8, v88
    v_lshl_add_u32 v88, v1, 4, v88
    s_add_u32 m0, s74, 11264
    s_add_u32 s78, s78, 16384
    buffer_load_dwordx4 v4, s[8:11], s78 offen lds
    v_and_b32 v89, 31, v0
    v_lshlrev_b32 v89, 2, v89
    v_lshrrev_b32 v16, 2, v0
    v_mul_u32_u24 v90, 3584, v16
    v_and_b32 v16, 1, v2
    v_lshlrev_b32 v16, 1, v16
    v_and_b32 v17, 3, v0
    v_xor_b32 v16, v16, v17
    v_lshl_add_u32 v90, v16, 4, v90
    s_mul_i32 s56, s44, 2304
    s_add_u32 s56, s56, 147456
    v_mul_u32_u24 v91, 144, v1
    v_lshlrev_b32 v92, 3, v2
    v_add3_u32 v91, v91, v92, s56
    s_add_u32 m0, s75, 131072
    s_mul_i32 s79, s73, 1536
    buffer_load_dwordx4 v30, s[12:15], s79 offen lds
    v_lshrrev_b32 v16, 3, v0
    v_mul_u32_u24 v16, 144, v16
    v_and_b32 v17, 0x70, v4
    v_add3_u32 v28, v16, v17, s56
    v_lshrrev_b32 v95, 3, v1
    v_lshlrev_b32 v95, 15, v95
    v_bfe_u32 v16, v1, 1, 1
    v_lshl_add_u32 v95, v16, 14, v95
    v_bfe_u32 v16, v1, 2, 1
    v_lshl_add_u32 v95, v16, 8, v95
    v_and_b32 v16, 1, v1
    v_lshl_add_u32 v95, v16, 7, v95
    v_mov_b32 v20, 0x3f803f80
    v_cmp_gt_u32 vcc, 8, v0
    buffer_load_dwordx4 v30, s[12:15], s79 offen offset:1024 lds
    s_add_u32 s73, s73, 128
    s_mul_i32 s56, s44, 20480
    v_add_u32 v16, s56, v3
    v_cndmask_b32 v20, 0, v20, vcc
    v_mov_b32 v21, v20
    v_mov_b32 v22, v20
    v_mov_b32 v23, v20
    ds_write_b128 v16, v[20:23] offset:0
    ds_write_b128 v16, v[20:23] offset:10240
    v_mov_b32 v20, 0
    v_mov_b32 v21, 0
    v_lshlrev_b32 v16, 3, v0
    s_lshl_b32 s56, s44, 9
    buffer_load_dwordx4 v30, s[12:15], s79 offen offset:2048 lds
    s_and_b32 s73, s73, 1023
    s_add_u32 s56, s56, 160768
    v_add_u32 v16, s56, v16
    ds_write_b64 v16, v[20:21]
    v_lshlrev_b32 v16, 2, v2
    v_sub_u32 v16, v1, v16
    v_mov_b32 v17, 0xf149f2ca
    s_cmp_eq_u32 s47, 0
    s_cselect_b64 s[6:7], -1, 0
    v_mov_b32 v19, 0xffff
    v_mov_b32 v20, 0xffff0000
    v_subrev_u32 v18, 0, v16
    v_cmp_lt_u32 vcc, 7, v18
    v_cmp_lt_i32 s[64:65], -9, v18
    v_cmp_le_i32 s[66:67], 0, v18
    v_mov_b32 v44, 0x3f803f80
    s_add_u32 m0, s75, 143360
    s_add_u32 s79, s79, 98304
    buffer_load_dwordx4 v30, s[12:15], s79 offen lds
    v_cndmask_b32 v32, 0, v17, vcc
    v_cndmask_b32 v36, 0, v17, s[64:65]
    v_cndmask_b32 v26, 0, v19, s[66:67]
    v_cndmask_b32 v40, v36, v17, s[6:7]
    v_subrev_u32 v18, 1, v16
    v_cmp_lt_u32 vcc, 7, v18
    v_cmp_lt_i32 s[64:65], -9, v18
    v_cmp_le_i32 s[66:67], 0, v18
    v_mov_b32 v45, 0x3f803f80
    v_cndmask_b32 v33, 0, v17, vcc
    v_cndmask_b32 v37, 0, v17, s[64:65]
    v_cndmask_b32 v21, 0, v20, s[66:67]
    v_or_b32 v26, v26, v21
    v_cndmask_b32 v41, v37, v17, s[6:7]
    buffer_load_dwordx4 v30, s[12:15], s79 offen offset:1024 lds
    v_subrev_u32 v18, 2, v16
    v_cmp_lt_u32 vcc, 7, v18
    v_cmp_lt_i32 s[64:65], -9, v18
    v_cmp_le_i32 s[66:67], 0, v18
    v_mov_b32 v46, 0x3f803f80
    v_cndmask_b32 v34, 0, v17, vcc
    v_cndmask_b32 v38, 0, v17, s[64:65]
    v_cndmask_b32 v27, 0, v19, s[66:67]
    v_cndmask_b32 v42, v38, v17, s[6:7]
    v_subrev_u32 v18, 3, v16
    v_cmp_lt_u32 vcc, 7, v18
    v_cmp_lt_i32 s[64:65], -9, v18
    v_cmp_le_i32 s[66:67], 0, v18
    v_mov_b32 v47, 0x3f803f80
    buffer_load_dwordx4 v30, s[12:15], s79 offen offset:2048 lds
    v_cndmask_b32 v35, 0, v17, vcc
    v_cndmask_b32 v39, 0, v17, s[64:65]
    v_cndmask_b32 v21, 0, v20, s[66:67]
    v_or_b32 v27, v27, v21
    v_cndmask_b32 v43, v39, v17, s[6:7]
    v_lshrrev_b32 v16, 2, v1
    v_cmp_eq_u32 s[64:65], v16, v2
    v_and_b32 v16, 3, v1
    v_cmp_eq_u32 s[66:67], 1, v16
    v_cmp_eq_u32 s[68:69], 2, v16
    v_cmp_eq_u32 s[70:71], 3, v16
    v_cmp_gt_u32 s[4:5], 2, v1
    s_mov_b32 s88, 0x3b000000
    s_mov_b32 s89, 0x3727c5ac
    s_add_u32 m0, s74, 20480
    s_add_u32 s78, s72, s73
    buffer_load_dwordx4 v4, s[8:11], s78 offen lds
    s_mov_b32 s90, 0x3eb8aa3b
    s_lshl_b32 s55, s48, 2
    s_add_u32 s55, s55, s44
    s_mul_i32 s54, s46, 7
    s_add_u32 s54, s54, s45
    s_sub_u32 s54, s54, 1
    s_cmp_eq_u32 s45, 0
    s_cselect_b32 s54, -1, s54
    s_cmp_lg_u32 s81, 1
    s_cselect_b32 s54, -1, s54
    s_lshl_b32 s56, s48, 16
    s_add_u32 s56, s56, 2097152
    s_lshl_b32 s57, s45, 2
    s_add_u32 s57, s57, s44
    s_add_u32 m0, s74, 21504
    s_add_u32 s78, s78, 16384
    buffer_load_dwordx4 v4, s[8:11], s78 offen lds
    s_lshl_b32 s94, s57, 9
    s_add_u32 s94, s94, s56
    s_lshl_b32 s95, s44, 14
    s_add_u32 s95, s95, s56
    s_lshl_b32 s57, s57, 2
    s_lshl_b32 s96, s48, 7
    s_add_u32 s96, s96, s57
    s_add_u32 s96, s96, 8192
    s_lshl_b32 s97, s55, 11
    s_lshl_b32 s57, s45, 7
    s_add_u32 s100, s97, s57
    s_add_u32 s100, s100, 655360
    s_add_u32 s97, s97, 131072
    s_add_u32 s91, s72, s57
    s_add_u32 m0, s75, 81920
    s_mul_i32 s79, s73, 1536
    buffer_load_dwordx4 v30, s[12:15], s79 offen lds
    s_lshl_b32 s98, s55, 4
    s_add_u32 s98, s98, 32768
    s_lshl_b32 s99, s46, 11
    s_add_u32 s99, s99, 32768
    s_lshr_b32 s85, s54, 31
    s_lshl_b32 s52, s46, 3
    s_add_u32 s52, s52, s45
    s_lshl_b32 s52, s52, 2
    s_add_u32 s52, s52, s44
    s_lshl_b32 s52, s52, 10
    s_add_u32 s52, s52, 4194304
    s_mul_i32 s101, s44, 14336
    s_lshl_b32 s57, s54, 7
    s_add_u32 s101, s101, s57
    buffer_load_dwordx4 v30, s[12:15], s79 offen offset:1024 lds
    s_add_u32 s73, s73, 128
    s_add_u32 s101, s101, 1179648
    v_mov_b32 v228, -1
    v_mov_b32 v229, -1
    v_mov_b32 v230, -1
    v_mov_b32 v231, -1
    v_lshlrev_b32 v232, 18, v2
    v_bfe_u32 v233, v0, 3, 1
    v_lshl_add_u32 v232, v233, 10, v232
    v_and_b32 v233, 7, v0
    v_lshl_add_u32 v232, v233, 4, v232
    s_mov_b32 exec_hi, 0
    buffer_store_dwordx4 v[228:231], v232, s[20:23], s100 offen sc1
    s_mov_b64 exec, -1
    s_cmp_lt_i32 s54, 0
    s_cbranch_scc1 LE_4
    v_lshrrev_b32 v234, 1, v2
    v_mul_u32_u24 v234, 57344, v234
    v_and_b32 v235, 1, v2
    v_mul_u32_u24 v235, 7168, v235
    v_add_u32 v234, v234, v235
    v_lshl_add_u32 v234, v1, 3, v234
    s_add_u32 s57, s101, 114688
    buffer_store_dwordx2 v[228:229], v234, s[20:23], s101 offen sc1
    buffer_store_dwordx2 v[228:229], v234, s[20:23], s57 offen sc1
LE_4:
    s_lshr_b32 s56, s2, 6
    s_cmp_lg_u32 s56, 0
    s_cbranch_scc1 LE_5
    buffer_store_dwordx4 v[228:231], v3, s[20:23], s52 offen sc1
LE_5:
    s_cmp_lg_u32 s2, 0
    s_cbranch_scc1 LE_6
    s_add_u32 s56, s77, 65536
    buffer_store_dwordx4 v[228:231], v3, s[20:23], s56 offen sc1
LE_6:
    s_waitcnt lgkmcnt(0)
    s_mul_i32 s56, s87, 0x9e3779b1
    s_mul_i32 s57, s83, 0x85ebca77
    s_add_u32 s49, s56, s57
    s_add_u32 s49, s49, 0x2545f491
    s_getreg_b32 s58, hwreg(HW_REG_XCC_ID, 0, 4)
    s_add_u32 s51, s49, s58
    s_cmp_lg_u32 s44, 0
    s_cbranch_scc1 LE_7
    v_mov_b32 v236, s51
    s_lshl_b32 s56, s48, 3
    s_add_u32 s56, s56, s45
    s_lshl_b32 s56, s56, 7
    s_add_u32 s56, s56, 98304
    s_mov_b64 exec, 1
    buffer_store_dword v236, off, s[20:23], s56 sc1
    s_mov_b64 exec, -1
LE_7:
    v_mov_b32 v104, 0
    v_mov_b32 v105, 0
    v_mov_b32 v106, 0
    v_mov_b32 v107, 0
    s_lshl_b32 s56, s48, 3
    s_add_u32 s56, s56, s45
    s_lshl_b32 s56, s56, 2
    s_add_u32 s56, s56, s44
    s_lshl_b32 s56, s56, 5
    s_add_u32 s56, s56, 1966080
    s_waitcnt vmcnt(22)
    v_dot2c_f32_bf16 v104, v96, v44
    v_dot2c_f32_bf16 v105, v100, v44
    v_dot2c_f32_bf16 v106, v96, v96
    v_dot2c_f32_bf16 v107, v100, v100
    v_dot2c_f32_bf16 v104, v97, v44
    v_dot2c_f32_bf16 v105, v101, v44
    v_dot2c_f32_bf16 v106, v97, v97
    v_dot2c_f32_bf16 v107, v101, v101
    v_dot2c_f32_bf16 v104, v98, v44
    v_dot2c_f32_bf16 v105, v102, v44
    v_dot2c_f32_bf16 v106, v98, v98
    v_dot2c_f32_bf16 v107, v102, v102
    v_dot2c_f32_bf16 v104, v99, v44
    v_dot2c_f32_bf16 v105, v103, v44
    v_dot2c_f32_bf16 v106, v99, v99
    v_dot2c_f32_bf16 v107, v103, v103
    v_lshrrev_b32 v98, 5, v0
    v_lshlrev_b32 v98, 4, v98
    v_permlane32_swap_b32 v104, v105
    v_permlane32_swap_b32 v106, v107
    v_add_f32 v104, v104, v105
    v_add_f32 v106, v106, v107
    v_mov_b32 v102, s49
    v_mov_b32 v103, 0
    v_permlane16_swap_b32 v104, v106
    v_add_f32 v104, v104, v106
    s_nop 1
    v_add_f32_dpp v104, v104, v104 row_ror:8 row_mask:0xf bank_mask:0xf
    v_and_b32 v96, 1, v2
    s_add_u32 s57, s44, 1
    v_add_f32_dpp v104, v104, v104 row_ror:4 row_mask:0xf bank_mask:0xf
    s_cmp_eq_u32 s47, 0
    s_cselect_b32 s58, 1, 0
    v_add_f32_dpp v104, v104, v104 row_ror:2 row_mask:0xf bank_mask:0xf
    v_cmp_eq_u32 vcc, 1, v96
    v_mov_b32 v96, s57
    v_add_f32_dpp v104, v104, v104 row_ror:1 row_mask:0xf bank_mask:0xf
    v_mov_b32 v97, s58
    v_cndmask_b32 v97, v96, v97, vcc
    v_mov_b32 v106, v104
    v_cndmask_b32_e64 v99, v96, 0, vcc
    v_lshlrev_b32 v96, 8, v97
    v_permlane16_swap_b32 v104, v106
    v_lshl_add_u32 v96, v1, 4, v96
    v_lshl_add_u32 v97, v99, 6, v13
    v_mul_f32 v100, s88, v104
    v_mul_f32 v106, s88, v106
    v_fma_f32 v106, -v100, v100, v106
    v_max_f32 v106, 0, v106
    v_add_f32 v101, s89, v106
    v_rsq_f32 v101, v101
    s_mov_b32 exec_lo, 1
    s_mov_b32 exec_hi, 1
    buffer_store_dwordx4 v[100:103], v98, s[20:23], s56 offen sc1
    s_mov_b64 exec, -1
    s_waitcnt vmcnt(12) lgkmcnt(0)
    s_barrier
    ds_read_b64_tr_b16 a[64:65], v15 offset:25600
    ds_read_b64_tr_b16 a[66:67], v15 offset:26112
    ds_read_b128 v[72:75], v5 offset:0
    ds_read_b64_tr_b16 a[128:129], v15 offset:26624
    ds_read_b64_tr_b16 a[130:131], v15 offset:27136
    ds_read_b64_tr_b16 a[0:1], v15 offset:24576
    ds_read_b64_tr_b16 a[2:3], v15 offset:25088
    ds_read_b128 v[76:79], v5 offset:2048
    ds_read_b128 v[80:83], v5 offset:4096
    ds_read_b128 v[84:87], v5 offset:6144
    ds_read_b128 v[120:123], v5 offset:8192
    s_waitcnt lgkmcnt(0)
    v_mfma_f32_16x16x32_bf16 v[152:155], a[64:67], v[72:75], 0
    ds_read_b64_tr_b16 a[68:69], v15 offset:37888
    v_mfma_f32_16x16x32_bf16 v[172:175], v[72:75], a[128:131], 0
    buffer_load_dwordx4 v30, s[12:15], s79 offen offset:2048 lds
    s_and_b32 s73, s73, 1023
    v_mfma_f32_16x16x32_bf16 v[192:195], a[0:3], v[72:75], 0
    ds_read_b64_tr_b16 a[70:71], v15 offset:38400
    s_add_u32 m0, s75, 94208
    v_mfma_f32_16x16x32_bf16 v[156:159], a[64:67], v[76:79], 0
    ds_read_b128 v[124:127], v6 offset:0
    s_add_u32 s79, s79, 98304
    v_mfma_f32_16x16x32_bf16 v[176:179], v[76:79], a[128:131], 0
    buffer_load_dwordx4 v30, s[12:15], s79 offen lds
    v_mfma_f32_16x16x32_bf16 v[196:199], a[0:3], v[76:79], 0
    ds_read_b64_tr_b16 a[132:133], v15 offset:38912
    v_mfma_f32_16x16x32_bf16 v[160:163], a[64:67], v[80:83], 0
    ds_read_b64_tr_b16 a[134:135], v15 offset:39424
    v_mfma_f32_16x16x32_bf16 v[180:183], v[80:83], a[128:131], 0
    buffer_load_dwordx4 v30, s[12:15], s79 offen offset:1024 lds
    v_mfma_f32_16x16x32_bf16 v[200:203], a[0:3], v[80:83], 0
    ds_read_b64_tr_b16 a[4:5], v15 offset:36864
    v_mfma_f32_16x16x32_bf16 v[164:167], a[64:67], v[84:87], 0
    ds_read_b64_tr_b16 a[6:7], v15 offset:37376
    v_mfma_f32_16x16x32_bf16 v[184:187], v[84:87], a[128:131], 0
    buffer_load_dwordx4 v30, s[12:15], s79 offen offset:2048 lds
    v_mfma_f32_16x16x32_bf16 v[204:207], a[0:3], v[84:87], 0
    ds_read_b128 v[128:131], v6 offset:2048
    s_add_u32 m0, s74, 30720
    v_mfma_f32_16x16x32_bf16 v[168:171], a[64:67], v[120:123], 0
    ds_read_b128 v[132:135], v6 offset:4096
    s_add_u32 s78, s72, s73
    v_mfma_f32_16x16x32_bf16 v[188:191], v[120:123], a[128:131], 0
    buffer_load_dwordx4 v4, s[8:11], s78 offen lds
    v_mfma_f32_16x16x32_bf16 v[208:211], a[0:3], v[120:123], 0
    ds_read_b128 v[136:139], v6 offset:6144
    s_add_u32 m0, s74, 31744
    ds_read_b128 v[140:143], v6 offset:8192
    s_add_u32 s78, s78, 16384
    buffer_load_dwordx4 v4, s[8:11], s78 offen lds
    s_waitcnt vmcnt(10) lgkmcnt(0)
    s_barrier
    v_mfma_f32_16x16x32_bf16 v[152:155], a[68:71], v[124:127], v[152:155]
    ds_read_b64_tr_b16 a[72:73], v15 offset:50176
    s_add_u32 m0, s75, 106496
    v_mfma_f32_16x16x32_bf16 v[172:175], v[124:127], a[132:135], v[172:175]
    s_mul_i32 s79, s73, 1536
    buffer_load_dwordx4 v30, s[12:15], s79 offen lds
    v_mfma_f32_16x16x32_bf16 v[192:195], a[4:7], v[124:127], v[192:195]
    ds_read_b64_tr_b16 a[74:75], v15 offset:50688
    v_mfma_f32_16x16x32_bf16 v[156:159], a[68:71], v[128:131], v[156:159]
    ds_read_b128 v[72:75], v5 offset:10240
    v_mfma_f32_16x16x32_bf16 v[176:179], v[128:131], a[132:135], v[176:179]
    buffer_load_dwordx4 v30, s[12:15], s79 offen offset:1024 lds
    s_add_u32 s73, s73, 128
    v_mfma_f32_16x16x32_bf16 v[196:199], a[4:7], v[128:131], v[196:199]
    ds_read_b64_tr_b16 a[136:137], v15 offset:51200
    v_mfma_f32_16x16x32_bf16 v[160:163], a[68:71], v[132:135], v[160:163]
    ds_read_b64_tr_b16 a[138:139], v15 offset:51712
    v_mfma_f32_16x16x32_bf16 v[180:183], v[132:135], a[132:135], v[180:183]
    buffer_load_dwordx4 v30, s[12:15], s79 offen offset:2048 lds
    s_and_b32 s73, s73, 1023
    v_mfma_f32_16x16x32_bf16 v[200:203], a[4:7], v[132:135], v[200:203]
    ds_read_b64_tr_b16 a[8:9], v15 offset:49152
    s_add_u32 m0, s75, 118784
    v_mfma_f32_16x16x32_bf16 v[164:167], a[68:71], v[136:139], v[164:167]
    ds_read_b64_tr_b16 a[10:11], v15 offset:49664
    s_add_u32 s79, s79, 98304
    v_mfma_f32_16x16x32_bf16 v[184:187], v[136:139], a[132:135], v[184:187]
    buffer_load_dwordx4 v30, s[12:15], s79 offen lds
    v_mfma_f32_16x16x32_bf16 v[204:207], a[4:7], v[136:139], v[204:207]
    ds_read_b128 v[76:79], v5 offset:12288
    v_mfma_f32_16x16x32_bf16 v[168:171], a[68:71], v[140:143], v[168:171]
    ds_read_b128 v[80:83], v5 offset:14336
    v_mfma_f32_16x16x32_bf16 v[188:191], v[140:143], a[132:135], v[188:191]
    buffer_load_dwordx4 v30, s[12:15], s79 offen offset:1024 lds
    v_mfma_f32_16x16x32_bf16 v[208:211], a[4:7], v[140:143], v[208:211]
    ds_read_b128 v[84:87], v5 offset:16384
    ds_read_b128 v[120:123], v5 offset:18432
    buffer_load_dwordx4 v30, s[12:15], s79 offen offset:2048 lds
    s_waitcnt lgkmcnt(0)
    v_mfma_f32_16x16x32_bf16 v[152:155], a[72:75], v[72:75], v[152:155]
    ds_read_b64_tr_b16 a[76:77], v15 offset:62464
    s_add_u32 m0, s74, 40960
    v_mfma_f32_16x16x32_bf16 v[172:175], v[72:75], a[136:139], v[172:175]
    s_add_u32 s78, s72, s73
    buffer_load_dwordx4 v4, s[8:11], s78 offen lds
    v_mfma_f32_16x16x32_bf16 v[192:195], a[8:11], v[72:75], v[192:195]
    ds_read_b64_tr_b16 a[78:79], v15 offset:62976
    s_add_u32 m0, s74, 41984
    v_mfma_f32_16x16x32_bf16 v[156:159], a[72:75], v[76:79], v[156:159]
    ds_read_b128 v[124:127], v6 offset:10240
    s_add_u32 s78, s78, 16384
    v_mfma_f32_16x16x32_bf16 v[176:179], v[76:79], a[136:139], v[176:179]
    buffer_load_dwordx4 v4, s[8:11], s78 offen lds
    v_mfma_f32_16x16x32_bf16 v[196:199], a[8:11], v[76:79], v[196:199]
    ds_read_b64_tr_b16 a[140:141], v15 offset:63488
    v_mfma_f32_16x16x32_bf16 v[160:163], a[72:75], v[80:83], v[160:163]
    ds_read_b64_tr_b16 a[142:143], v15 offset:64000
    v_mfma_f32_16x16x32_bf16 v[180:183], v[80:83], a[136:139], v[180:183]
    ds_read_b64_tr_b16 a[12:13], v15 offset:61440
    v_mfma_f32_16x16x32_bf16 v[200:203], a[8:11], v[80:83], v[200:203]
    ds_read_b64_tr_b16 a[14:15], v15 offset:61952
    v_mfma_f32_16x16x32_bf16 v[164:167], a[72:75], v[84:87], v[164:167]
    ds_read_b128 v[128:131], v6 offset:12288
    v_mfma_f32_16x16x32_bf16 v[184:187], v[84:87], a[136:139], v[184:187]
    ds_read_b128 v[132:135], v6 offset:14336
    v_mfma_f32_16x16x32_bf16 v[204:207], a[8:11], v[84:87], v[204:207]
    ds_read_b128 v[136:139], v6 offset:16384
    v_mfma_f32_16x16x32_bf16 v[168:171], a[72:75], v[120:123], v[168:171]
    ds_read_b128 v[140:143], v6 offset:18432
    v_mfma_f32_16x16x32_bf16 v[188:191], v[120:123], a[136:139], v[188:191]
    v_mfma_f32_16x16x32_bf16 v[208:211], a[8:11], v[120:123], v[208:211]
    s_waitcnt vmcnt(10) lgkmcnt(0)
    s_barrier
    v_mfma_f32_16x16x32_bf16 v[152:155], a[76:79], v[124:127], v[152:155]
    ds_read_b64_tr_b16 a[80:81], v15 offset:1024
    s_add_u32 m0, s75, 131072
    v_mfma_f32_16x16x32_bf16 v[172:175], v[124:127], a[140:143], v[172:175]
    s_mul_i32 s79, s73, 1536
    buffer_load_dwordx4 v30, s[12:15], s79 offen lds
    v_mfma_f32_16x16x32_bf16 v[192:195], a[12:15], v[124:127], v[192:195]
    ds_read_b64_tr_b16 a[82:83], v15 offset:1536
    v_mfma_f32_16x16x32_bf16 v[156:159], a[76:79], v[128:131], v[156:159]
    ds_read_b128 v[72:75], v5 offset:20480
    v_mfma_f32_16x16x32_bf16 v[176:179], v[128:131], a[140:143], v[176:179]
    buffer_load_dwordx4 v30, s[12:15], s79 offen offset:1024 lds
    s_add_u32 s73, s73, 128
    v_mfma_f32_16x16x32_bf16 v[196:199], a[12:15], v[128:131], v[196:199]
    ds_read_b64_tr_b16 a[144:145], v15 offset:2048
    v_mfma_f32_16x16x32_bf16 v[160:163], a[76:79], v[132:135], v[160:163]
    ds_read_b64_tr_b16 a[146:147], v15 offset:2560
    v_mfma_f32_16x16x32_bf16 v[180:183], v[132:135], a[140:143], v[180:183]
    buffer_load_dwordx4 v30, s[12:15], s79 offen offset:2048 lds
    s_and_b32 s73, s73, 1023
    v_mfma_f32_16x16x32_bf16 v[200:203], a[12:15], v[132:135], v[200:203]
    ds_read_b64_tr_b16 a[16:17], v15 offset:0
    s_add_u32 m0, s75, 143360
    v_mfma_f32_16x16x32_bf16 v[164:167], a[76:79], v[136:139], v[164:167]
    ds_read_b64_tr_b16 a[18:19], v15 offset:512
    s_add_u32 s79, s79, 98304
    v_mfma_f32_16x16x32_bf16 v[184:187], v[136:139], a[140:143], v[184:187]
    buffer_load_dwordx4 v30, s[12:15], s79 offen lds
    v_mfma_f32_16x16x32_bf16 v[204:207], a[12:15], v[136:139], v[204:207]
    ds_read_b128 v[76:79], v5 offset:22528
    v_mfma_f32_16x16x32_bf16 v[168:171], a[76:79], v[140:143], v[168:171]
    ds_read_b128 v[80:83], v5 offset:24576
    v_mfma_f32_16x16x32_bf16 v[188:191], v[140:143], a[140:143], v[188:191]
    buffer_load_dwordx4 v30, s[12:15], s79 offen offset:1024 lds
    v_mfma_f32_16x16x32_bf16 v[208:211], a[12:15], v[140:143], v[208:211]
    ds_read_b128 v[84:87], v5 offset:26624
    ds_read_b128 v[120:123], v5 offset:28672
    buffer_load_dwordx4 v30, s[12:15], s79 offen offset:2048 lds
    s_waitcnt lgkmcnt(0)
    v_mfma_f32_16x16x32_bf16 v[152:155], a[80:83], v[72:75], v[152:155]
    ds_read_b64_tr_b16 a[84:85], v15 offset:13312
    s_add_u32 m0, s74, 51200
    v_mfma_f32_16x16x32_bf16 v[172:175], v[72:75], a[144:147], v[172:175]
    s_add_u32 s78, s72, s73
    buffer_load_dwordx4 v4, s[8:11], s78 offen lds
    v_mfma_f32_16x16x32_bf16 v[192:195], a[16:19], v[72:75], v[192:195]
    ds_read_b64_tr_b16 a[86:87], v15 offset:13824
    s_add_u32 m0, s74, 52224
    v_mfma_f32_16x16x32_bf16 v[156:159], a[80:83], v[76:79], v[156:159]
    ds_read_b128 v[124:127], v6 offset:20480
    s_add_u32 s78, s78, 16384
    v_mfma_f32_16x16x32_bf16 v[176:179], v[76:79], a[144:147], v[176:179]
    buffer_load_dwordx4 v4, s[8:11], s78 offen lds
    v_mfma_f32_16x16x32_bf16 v[196:199], a[16:19], v[76:79], v[196:199]
    ds_read_b64_tr_b16 a[148:149], v15 offset:14336
    v_mfma_f32_16x16x32_bf16 v[160:163], a[80:83], v[80:83], v[160:163]
    ds_read_b64_tr_b16 a[150:151], v15 offset:14848
    v_mfma_f32_16x16x32_bf16 v[180:183], v[80:83], a[144:147], v[180:183]
    ds_read_b64_tr_b16 a[20:21], v15 offset:12288
    v_mfma_f32_16x16x32_bf16 v[200:203], a[16:19], v[80:83], v[200:203]
    ds_read_b64_tr_b16 a[22:23], v15 offset:12800
    v_mfma_f32_16x16x32_bf16 v[164:167], a[80:83], v[84:87], v[164:167]
    ds_read_b128 v[128:131], v6 offset:22528
    v_mfma_f32_16x16x32_bf16 v[184:187], v[84:87], a[144:147], v[184:187]
    ds_read_b128 v[132:135], v6 offset:24576
    v_mfma_f32_16x16x32_bf16 v[204:207], a[16:19], v[84:87], v[204:207]
    ds_read_b128 v[136:139], v6 offset:26624
    v_mfma_f32_16x16x32_bf16 v[168:171], a[80:83], v[120:123], v[168:171]
    ds_read_b128 v[140:143], v6 offset:28672
    v_mfma_f32_16x16x32_bf16 v[188:191], v[120:123], a[144:147], v[188:191]
    v_mfma_f32_16x16x32_bf16 v[208:211], a[16:19], v[120:123], v[208:211]
    s_waitcnt vmcnt(10) lgkmcnt(0)
    s_barrier
    v_and_b32 v112, 7, v0
    v_lshlrev_b32 v112, 7, v112
    s_lshl_b32 s63, s48, 10
    s_add_u32 s63, s63, 98304
    buffer_load_dword v113, v112, s[20:23], s63 offen sc1
    s_cmp_lg_u32 s45, 0
    s_cbranch_scc1 LN_8
    s_mov_b32 s61, m0
    s_mov_b32 m0, 162816
    v_lshlrev_b32 v235, 7, v1
    v_and_b32 v236, 1, v2
    v_lshl_add_u32 v235, v236, 18, v235
    v_add_u32 v235, s97, v235
    v_and_b32 v236, 3, v0
    v_lshlrev_b32 v236, 12, v236
    s_and_b32 s56, s96, 0xffffff80
    v_add_u32 v236, s56, v236
    v_cmp_gt_u32 vcc, 32, v0
    s_nop 1
    v_cndmask_b32 v235, v236, v235, vcc
    buffer_load_dword v235, s[20:23], 0 offen lds
    s_mov_b32 m0, s61
LN_8:
    v_mfma_f32_16x16x32_bf16 v[152:155], a[84:87], v[124:127], v[152:155]
    ds_read_b64_tr_b16 a[88:89], v15 offset:25600
    s_add_u32 m0, s75, 81920
    v_mfma_f32_16x16x32_bf16 v[172:175], v[124:127], a[148:151], v[172:175]
    s_mul_i32 s79, s73, 1536
    buffer_load_dwordx4 v30, s[12:15], s79 offen lds
    v_mfma_f32_16x16x32_bf16 v[192:195], a[20:23], v[124:127], v[192:195]
    ds_read_b64_tr_b16 a[90:91], v15 offset:26112
    v_mfma_f32_16x16x32_bf16 v[156:159], a[84:87], v[128:131], v[156:159]
    ds_read_b128 v[72:75], v5 offset:30720
    v_mfma_f32_16x16x32_bf16 v[176:179], v[128:131], a[148:151], v[176:179]
    buffer_load_dwordx4 v30, s[12:15], s79 offen offset:1024 lds
    s_add_u32 s73, s73, 128
    v_mfma_f32_16x16x32_bf16 v[196:199], a[20:23], v[128:131], v[196:199]
    ds_read_b64_tr_b16 a[152:153], v15 offset:26624
    v_mfma_f32_16x16x32_bf16 v[160:163], a[84:87], v[132:135], v[160:163]
    ds_read_b64_tr_b16 a[154:155], v15 offset:27136
    v_mfma_f32_16x16x32_bf16 v[180:183], v[132:135], a[148:151], v[180:183]
    buffer_load_dwordx4 v30, s[12:15], s79 offen offset:2048 lds
    s_and_b32 s73, s73, 1023
    v_mfma_f32_16x16x32_bf16 v[200:203], a[20:23], v[132:135], v[200:203]
    ds_read_b64_tr_b16 a[24:25], v15 offset:24576
    s_add_u32 m0, s75, 94208
    v_mfma_f32_16x16x32_bf16 v[164:167], a[84:87], v[136:139], v[164:167]
    ds_read_b64_tr_b16 a[26:27], v15 offset:25088
    s_add_u32 s79, s79, 98304
    v_mfma_f32_16x16x32_bf16 v[184:187], v[136:139], a[148:151], v[184:187]
    buffer_load_dwordx4 v30, s[12:15], s79 offen lds
    v_mfma_f32_16x16x32_bf16 v[204:207], a[20:23], v[136:139], v[204:207]
    ds_read_b128 v[76:79], v5 offset:32768
    v_mfma_f32_16x16x32_bf16 v[168:171], a[84:87], v[140:143], v[168:171]
    ds_read_b128 v[80:83], v5 offset:34816
    v_mfma_f32_16x16x32_bf16 v[188:191], v[140:143], a[148:151], v[188:191]
    buffer_load_dwordx4 v30, s[12:15], s79 offen offset:1024 lds
    v_mfma_f32_16x16x32_bf16 v[208:211], a[20:23], v[140:143], v[208:211]
    ds_read_b128 v[84:87], v5 offset:36864
    ds_read_b128 v[120:123], v5 offset:38912
    buffer_load_dwordx4 v30, s[12:15], s79 offen offset:2048 lds
    s_waitcnt lgkmcnt(0)
    v_mfma_f32_16x16x32_bf16 v[152:155], a[88:91], v[72:75], v[152:155]
    ds_read_b64_tr_b16 a[92:93], v15 offset:37888
    s_add_u32 m0, s74, 61440
    v_mfma_f32_16x16x32_bf16 v[172:175], v[72:75], a[152:155], v[172:175]
    s_add_u32 s78, s72, s73
    buffer_load_dwordx4 v4, s[8:11], s78 offen lds
    v_mfma_f32_16x16x32_bf16 v[192:195], a[24:27], v[72:75], v[192:195]
    ds_read_b64_tr_b16 a[94:95], v15 offset:38400
    s_add_u32 m0, s74, 62464
    v_mfma_f32_16x16x32_bf16 v[156:159], a[88:91], v[76:79], v[156:159]
    ds_read_b128 v[124:127], v6 offset:30720
    s_add_u32 s78, s78, 16384
    v_mfma_f32_16x16x32_bf16 v[176:179], v[76:79], a[152:155], v[176:179]
    buffer_load_dwordx4 v4, s[8:11], s78 offen lds
    v_mfma_f32_16x16x32_bf16 v[196:199], a[24:27], v[76:79], v[196:199]
    ds_read_b64_tr_b16 a[156:157], v15 offset:38912
    v_mfma_f32_16x16x32_bf16 v[160:163], a[88:91], v[80:83], v[160:163]
    ds_read_b64_tr_b16 a[158:159], v15 offset:39424
    v_mfma_f32_16x16x32_bf16 v[180:183], v[80:83], a[152:155], v[180:183]
    ds_read_b64_tr_b16 a[28:29], v15 offset:36864
    v_mfma_f32_16x16x32_bf16 v[200:203], a[24:27], v[80:83], v[200:203]
    ds_read_b64_tr_b16 a[30:31], v15 offset:37376
    v_mfma_f32_16x16x32_bf16 v[164:167], a[88:91], v[84:87], v[164:167]
    ds_read_b128 v[128:131], v6 offset:32768
    v_mfma_f32_16x16x32_bf16 v[184:187], v[84:87], a[152:155], v[184:187]
    ds_read_b128 v[132:135], v6 offset:34816
    v_mfma_f32_16x16x32_bf16 v[204:207], a[24:27], v[84:87], v[204:207]
    ds_read_b128 v[136:139], v6 offset:36864
    v_mfma_f32_16x16x32_bf16 v[168:171], a[88:91], v[120:123], v[168:171]
    ds_read_b128 v[140:143], v6 offset:38912
    v_mfma_f32_16x16x32_bf16 v[188:191], v[120:123], a[152:155], v[188:191]
    v_mfma_f32_16x16x32_bf16 v[208:211], a[24:27], v[120:123], v[208:211]
    s_waitcnt vmcnt(10) lgkmcnt(0)
    s_barrier
    s_lshl_b32 s62, s48, 10
    s_add_u32 s62, s62, 1965824
    buffer_load_dwordx4 v[108:111], v96, s[20:23], s62 offen sc1
    v_mfma_f32_16x16x32_bf16 v[152:155], a[92:95], v[124:127], v[152:155]
    ds_read_b64_tr_b16 a[96:97], v15 offset:50176
    s_add_u32 m0, s75, 106496
    v_mfma_f32_16x16x32_bf16 v[172:175], v[124:127], a[156:159], v[172:175]
    s_mul_i32 s79, s73, 1536
    buffer_load_dwordx4 v30, s[12:15], s79 offen lds
    v_mfma_f32_16x16x32_bf16 v[192:195], a[28:31], v[124:127], v[192:195]
    ds_read_b64_tr_b16 a[98:99], v15 offset:50688
    v_mfma_f32_16x16x32_bf16 v[156:159], a[92:95], v[128:131], v[156:159]
    ds_read_b128 v[72:75], v7 offset:0
    v_mfma_f32_16x16x32_bf16 v[176:179], v[128:131], a[156:159], v[176:179]
    buffer_load_dwordx4 v30, s[12:15], s79 offen offset:1024 lds
    s_add_u32 s73, s73, 128
    v_mfma_f32_16x16x32_bf16 v[196:199], a[28:31], v[128:131], v[196:199]
    ds_read_b64_tr_b16 a[160:161], v15 offset:51200
    v_mfma_f32_16x16x32_bf16 v[160:163], a[92:95], v[132:135], v[160:163]
    ds_read_b64_tr_b16 a[162:163], v15 offset:51712
    v_mfma_f32_16x16x32_bf16 v[180:183], v[132:135], a[156:159], v[180:183]
    buffer_load_dwordx4 v30, s[12:15], s79 offen offset:2048 lds
    s_and_b32 s73, s73, 1023
    v_mfma_f32_16x16x32_bf16 v[200:203], a[28:31], v[132:135], v[200:203]
    ds_read_b64_tr_b16 a[32:33], v15 offset:49152
    s_add_u32 m0, s75, 118784
    v_mfma_f32_16x16x32_bf16 v[164:167], a[92:95], v[136:139], v[164:167]
    ds_read_b64_tr_b16 a[34:35], v15 offset:49664
    s_add_u32 s79, s79, 98304
    v_mfma_f32_16x16x32_bf16 v[184:187], v[136:139], a[156:159], v[184:187]
    buffer_load_dwordx4 v30, s[12:15], s79 offen lds
    v_mfma_f32_16x16x32_bf16 v[204:207], a[28:31], v[136:139], v[204:207]
    ds_read_b128 v[76:79], v7 offset:2048
    v_mfma_f32_16x16x32_bf16 v[168:171], a[92:95], v[140:143], v[168:171]
    ds_read_b128 v[80:83], v7 offset:4096
    v_mfma_f32_16x16x32_bf16 v[188:191], v[140:143], a[156:159], v[188:191]
    buffer_load_dwordx4 v30, s[12:15], s79 offen offset:1024 lds
    v_mfma_f32_16x16x32_bf16 v[208:211], a[28:31], v[140:143], v[208:211]
    ds_read_b128 v[84:87], v7 offset:6144
    ds_read_b128 v[120:123], v7 offset:8192
    buffer_load_dwordx4 v30, s[12:15], s79 offen offset:2048 lds
    s_waitcnt lgkmcnt(0)
    v_mfma_f32_16x16x32_bf16 v[152:155], a[96:99], v[72:75], v[152:155]
    ds_read_b64_tr_b16 a[100:101], v15 offset:62464
    s_add_u32 m0, s74, 71680
    v_mfma_f32_16x16x32_bf16 v[172:175], v[72:75], a[160:163], v[172:175]
    s_add_u32 s78, s72, s73
    buffer_load_dwordx4 v4, s[8:11], s78 offen lds
    v_mfma_f32_16x16x32_bf16 v[192:195], a[32:35], v[72:75], v[192:195]
    ds_read_b64_tr_b16 a[102:103], v15 offset:62976
    s_add_u32 m0, s74, 72704
    v_mfma_f32_16x16x32_bf16 v[156:159], a[96:99], v[76:79], v[156:159]
    ds_read_b128 v[124:127], v8 offset:0
    s_add_u32 s78, s78, 16384
    v_mfma_f32_16x16x32_bf16 v[176:179], v[76:79], a[160:163], v[176:179]
    buffer_load_dwordx4 v4, s[8:11], s78 offen lds
    v_mfma_f32_16x16x32_bf16 v[196:199], a[32:35], v[76:79], v[196:199]
    ds_read_b64_tr_b16 a[164:165], v15 offset:63488
    v_mfma_f32_16x16x32_bf16 v[160:163], a[96:99], v[80:83], v[160:163]
    ds_read_b64_tr_b16 a[166:167], v15 offset:64000
    v_mfma_f32_16x16x32_bf16 v[180:183], v[80:83], a[160:163], v[180:183]
    ds_read_b64_tr_b16 a[36:37], v15 offset:61440
    v_mfma_f32_16x16x32_bf16 v[200:203], a[32:35], v[80:83], v[200:203]
    ds_read_b64_tr_b16 a[38:39], v15 offset:61952
    v_mfma_f32_16x16x32_bf16 v[164:167], a[96:99], v[84:87], v[164:167]
    ds_read_b128 v[128:131], v8 offset:2048
    v_mfma_f32_16x16x32_bf16 v[184:187], v[84:87], a[160:163], v[184:187]
    ds_read_b128 v[132:135], v8 offset:4096
    v_mfma_f32_16x16x32_bf16 v[204:207], a[32:35], v[84:87], v[204:207]
    ds_read_b128 v[136:139], v8 offset:6144
    v_mfma_f32_16x16x32_bf16 v[168:171], a[96:99], v[120:123], v[168:171]
    ds_read_b128 v[140:143], v8 offset:8192
    v_mfma_f32_16x16x32_bf16 v[188:191], v[120:123], a[160:163], v[188:191]
    v_mfma_f32_16x16x32_bf16 v[208:211], a[32:35], v[120:123], v[208:211]
    s_waitcnt vmcnt(10) lgkmcnt(0)
    s_barrier
    s_mov_b32 s61, m0
    s_mov_b32 m0, 162816
    s_lshr_b32 s56, s2, 3
    s_lshl_b32 s56, s56, 2
    s_add_u32 s56, s56, s44
    s_cmp_ge_u32 s56, 64
    s_cbranch_scc1 LF_9
    v_lshrrev_b32 v235, 2, v0
    v_mul_u32_u24 v235, 3584, v235
    v_and_b32 v236, 3, v0
    v_lshl_add_u32 v235, v236, 7, v235
    s_and_b32 s57, s56, 31
    s_mul_i32 s57, s57, 57344
    s_mul_i32 s58, s46, 448
    s_and_b32 s58, s58, 0xffffff80
    s_add_u32 s57, s57, s58
    s_cmp_ge_u32 s56, 32
    s_cbranch_scc1 LF_10
    buffer_load_dword v235, s[28:31], s57 offen lds
    s_branch LF_11
LF_10:
    buffer_load_dword v235, s[32:35], s57 offen lds
    s_branch LF_11
LF_9:
    s_cmp_ge_u32 s56, 92
    s_cbranch_scc1 LF_11
    v_lshlrev_b32 v235, 7, v0
    s_sub_u32 s56, s56, 64
    s_lshl_b32 s56, s56, 13
    s_mul_i32 s57, s46, 229376
    s_add_u32 s56, s56, s57
    buffer_load_dword v235, s[36:39], s56 offen lds
LF_11:
    s_mov_b32 m0, s61
    v_mfma_f32_16x16x32_bf16 v[152:155], a[100:103], v[124:127], v[152:155]
    ds_read_b64_tr_b16 a[104:105], v15 offset:1024
    s_add_u32 m0, s75, 131072
    v_mfma_f32_16x16x32_bf16 v[172:175], v[124:127], a[164:167], v[172:175]
    s_mul_i32 s79, s73, 1536
    buffer_load_dwordx4 v30, s[12:15], s79 offen lds
    v_mfma_f32_16x16x32_bf16 v[192:195], a[36:39], v[124:127], v[192:195]
    ds_read_b64_tr_b16 a[106:107], v15 offset:1536
    v_mfma_f32_16x16x32_bf16 v[156:159], a[100:103], v[128:131], v[156:159]
    ds_read_b128 v[72:75], v7 offset:10240
    v_mfma_f32_16x16x32_bf16 v[176:179], v[128:131], a[164:167], v[176:179]
    buffer_load_dwordx4 v30, s[12:15], s79 offen offset:1024 lds
    s_add_u32 s73, s73, 128
    v_mfma_f32_16x16x32_bf16 v[196:199], a[36:39], v[128:131], v[196:199]
    ds_read_b64_tr_b16 a[168:169], v15 offset:2048
    v_mfma_f32_16x16x32_bf16 v[160:163], a[100:103], v[132:135], v[160:163]
    ds_read_b64_tr_b16 a[170:171], v15 offset:2560
    v_mfma_f32_16x16x32_bf16 v[180:183], v[132:135], a[164:167], v[180:183]
    buffer_load_dwordx4 v30, s[12:15], s79 offen offset:2048 lds
    s_and_b32 s73, s73, 1023
    v_mfma_f32_16x16x32_bf16 v[200:203], a[36:39], v[132:135], v[200:203]
    ds_read_b64_tr_b16 a[40:41], v15 offset:0
    s_add_u32 m0, s75, 143360
    v_mfma_f32_16x16x32_bf16 v[164:167], a[100:103], v[136:139], v[164:167]
    ds_read_b64_tr_b16 a[42:43], v15 offset:512
    s_add_u32 s79, s79, 98304
    v_mfma_f32_16x16x32_bf16 v[184:187], v[136:139], a[164:167], v[184:187]
    buffer_load_dwordx4 v30, s[12:15], s79 offen lds
    v_mfma_f32_16x16x32_bf16 v[204:207], a[36:39], v[136:139], v[204:207]
    ds_read_b128 v[76:79], v7 offset:12288
    v_mfma_f32_16x16x32_bf16 v[168:171], a[100:103], v[140:143], v[168:171]
    ds_read_b128 v[80:83], v7 offset:14336
    v_mfma_f32_16x16x32_bf16 v[188:191], v[140:143], a[164:167], v[188:191]
    buffer_load_dwordx4 v30, s[12:15], s79 offen offset:1024 lds
    v_mfma_f32_16x16x32_bf16 v[208:211], a[36:39], v[140:143], v[208:211]
    ds_read_b128 v[84:87], v7 offset:16384
    ds_read_b128 v[120:123], v7 offset:18432
    buffer_load_dwordx4 v30, s[12:15], s79 offen offset:2048 lds
    s_waitcnt lgkmcnt(0)
    v_mfma_f32_16x16x32_bf16 v[152:155], a[104:107], v[72:75], v[152:155]
    ds_read_b64_tr_b16 a[108:109], v15 offset:13312
    v_mfma_f32_16x16x32_bf16 v[172:175], v[72:75], a[168:171], v[172:175]
    ds_read_b64_tr_b16 a[110:111], v15 offset:13824
    v_mfma_f32_16x16x32_bf16 v[192:195], a[40:43], v[72:75], v[192:195]
    ds_read_b128 v[124:127], v8 offset:10240
    v_mfma_f32_16x16x32_bf16 v[156:159], a[104:107], v[76:79], v[156:159]
    ds_read_b64_tr_b16 a[172:173], v15 offset:14336
    v_mfma_f32_16x16x32_bf16 v[176:179], v[76:79], a[168:171], v[176:179]
    ds_read_b64_tr_b16 a[174:175], v15 offset:14848
    v_mfma_f32_16x16x32_bf16 v[196:199], a[40:43], v[76:79], v[196:199]
    ds_read_b64_tr_b16 a[44:45], v15 offset:12288
    v_mfma_f32_16x16x32_bf16 v[160:163], a[104:107], v[80:83], v[160:163]
    ds_read_b64_tr_b16 a[46:47], v15 offset:12800
    v_mfma_f32_16x16x32_bf16 v[180:183], v[80:83], a[168:171], v[180:183]
    ds_read_b128 v[128:131], v8 offset:12288
    v_mfma_f32_16x16x32_bf16 v[200:203], a[40:43], v[80:83], v[200:203]
    ds_read_b128 v[132:135], v8 offset:14336
    v_mfma_f32_16x16x32_bf16 v[164:167], a[104:107], v[84:87], v[164:167]
    ds_read_b128 v[136:139], v8 offset:16384
    v_mfma_f32_16x16x32_bf16 v[184:187], v[84:87], a[168:171], v[184:187]
    ds_read_b128 v[140:143], v8 offset:18432
    v_mfma_f32_16x16x32_bf16 v[204:207], a[40:43], v[84:87], v[204:207]
    v_mfma_f32_16x16x32_bf16 v[168:171], a[104:107], v[120:123], v[168:171]
    v_mfma_f32_16x16x32_bf16 v[188:191], v[120:123], a[168:171], v[188:191]
    v_mfma_f32_16x16x32_bf16 v[208:211], a[40:43], v[120:123], v[208:211]
    s_waitcnt vmcnt(8) lgkmcnt(0)
    s_barrier
    v_cmp_ne_u32 vcc, s49, v110
    s_cbranch_vccnz L_SRETRY
L_SOK:
    ds_write2_b32 v97, v108, v109 offset0:0 offset1:80
    v_mfma_f32_16x16x32_bf16 v[152:155], a[108:111], v[124:127], v[152:155]
    ds_read_b64_tr_b16 a[112:113], v15 offset:25600
    s_add_u32 m0, s77, 81920
    v_mfma_f32_16x16x32_bf16 v[172:175], v[124:127], a[172:175], v[172:175]
    s_mov_b32 s78, 0
    buffer_load_dwordx4 v31, s[16:19], s78 offen lds
    v_mfma_f32_16x16x32_bf16 v[192:195], a[44:47], v[124:127], v[192:195]
    ds_read_b64_tr_b16 a[114:115], v15 offset:26112
    s_add_u32 m0, s77, 86016
    v_mfma_f32_16x16x32_bf16 v[156:159], a[108:111], v[128:131], v[156:159]
    ds_read_b128 v[72:75], v7 offset:20480
    s_mov_b32 s78, 32768
    v_mfma_f32_16x16x32_bf16 v[176:179], v[128:131], a[172:175], v[176:179]
    buffer_load_dwordx4 v31, s[16:19], s78 offen lds
    v_mfma_f32_16x16x32_bf16 v[196:199], a[44:47], v[128:131], v[196:199]
    ds_read_b64_tr_b16 a[176:177], v15 offset:26624
    s_add_u32 m0, s77, 90112
    v_mfma_f32_16x16x32_bf16 v[160:163], a[108:111], v[132:135], v[160:163]
    ds_read_b64_tr_b16 a[178:179], v15 offset:27136
    s_mov_b32 s78, 65536
    v_mfma_f32_16x16x32_bf16 v[180:183], v[132:135], a[172:175], v[180:183]
    buffer_load_dwordx4 v31, s[16:19], s78 offen lds
    v_mfma_f32_16x16x32_bf16 v[200:203], a[44:47], v[132:135], v[200:203]
    ds_read_b64_tr_b16 a[48:49], v15 offset:24576
    s_add_u32 m0, s77, 94208
    v_mfma_f32_16x16x32_bf16 v[164:167], a[108:111], v[136:139], v[164:167]
    ds_read_b64_tr_b16 a[50:51], v15 offset:25088
    s_mov_b32 s78, 98304
    v_mfma_f32_16x16x32_bf16 v[184:187], v[136:139], a[172:175], v[184:187]
    buffer_load_dwordx4 v31, s[16:19], s78 offen lds
    v_mfma_f32_16x16x32_bf16 v[204:207], a[44:47], v[136:139], v[204:207]
    ds_read_b128 v[76:79], v7 offset:22528
    s_add_u32 m0, s77, 98304
    v_mfma_f32_16x16x32_bf16 v[168:171], a[108:111], v[140:143], v[168:171]
    ds_read_b128 v[80:83], v7 offset:24576
    s_mov_b32 s78, 131072
    v_mfma_f32_16x16x32_bf16 v[188:191], v[140:143], a[172:175], v[188:191]
    buffer_load_dwordx4 v31, s[16:19], s78 offen lds
    v_mfma_f32_16x16x32_bf16 v[208:211], a[44:47], v[140:143], v[208:211]
    ds_read_b128 v[84:87], v7 offset:26624
    s_add_u32 m0, s77, 102400
    ds_read_b128 v[120:123], v7 offset:28672
    s_mov_b32 s78, 163840
    buffer_load_dwordx4 v31, s[16:19], s78 offen lds
    s_waitcnt lgkmcnt(0)
    v_mfma_f32_16x16x32_bf16 v[152:155], a[112:115], v[72:75], v[152:155]
    ds_read_b64_tr_b16 a[116:117], v15 offset:37888
    v_mfma_f32_16x16x32_bf16 v[172:175], v[72:75], a[176:179], v[172:175]
    ds_read_b64_tr_b16 a[118:119], v15 offset:38400
    v_mfma_f32_16x16x32_bf16 v[192:195], a[48:51], v[72:75], v[192:195]
    ds_read_b128 v[124:127], v8 offset:20480
    v_mfma_f32_16x16x32_bf16 v[156:159], a[112:115], v[76:79], v[156:159]
    ds_read_b64_tr_b16 a[180:181], v15 offset:38912
    v_mfma_f32_16x16x32_bf16 v[176:179], v[76:79], a[176:179], v[176:179]
    ds_read_b64_tr_b16 a[182:183], v15 offset:39424
    v_mfma_f32_16x16x32_bf16 v[196:199], a[48:51], v[76:79], v[196:199]
    ds_read_b64_tr_b16 a[52:53], v15 offset:36864
    v_mfma_f32_16x16x32_bf16 v[160:163], a[112:115], v[80:83], v[160:163]
    ds_read_b64_tr_b16 a[54:55], v15 offset:37376
    v_mfma_f32_16x16x32_bf16 v[180:183], v[80:83], a[176:179], v[180:183]
    ds_read_b128 v[128:131], v8 offset:22528
    v_mfma_f32_16x16x32_bf16 v[200:203], a[48:51], v[80:83], v[200:203]
    ds_read_b128 v[132:135], v8 offset:24576
    v_mfma_f32_16x16x32_bf16 v[164:167], a[112:115], v[84:87], v[164:167]
    ds_read_b128 v[136:139], v8 offset:26624
    v_mfma_f32_16x16x32_bf16 v[184:187], v[84:87], a[176:179], v[184:187]
    ds_read_b128 v[140:143], v8 offset:28672
    v_mfma_f32_16x16x32_bf16 v[204:207], a[48:51], v[84:87], v[204:207]
    v_mfma_f32_16x16x32_bf16 v[168:171], a[112:115], v[120:123], v[168:171]
    v_mfma_f32_16x16x32_bf16 v[188:191], v[120:123], a[176:179], v[188:191]
    v_mfma_f32_16x16x32_bf16 v[208:211], a[48:51], v[120:123], v[208:211]
    s_waitcnt vmcnt(6) lgkmcnt(0)
    s_barrier
    v_mfma_f32_16x16x32_bf16 v[152:155], a[116:119], v[124:127], v[152:155]
    ds_read_b64_tr_b16 a[120:121], v15 offset:50176
    v_mfma_f32_16x16x32_bf16 v[172:175], v[124:127], a[180:183], v[172:175]
    ds_read_b64_tr_b16 a[122:123], v15 offset:50688
    v_mfma_f32_16x16x32_bf16 v[192:195], a[52:55], v[124:127], v[192:195]
    ds_read_b128 v[72:75], v7 offset:30720
    v_mfma_f32_16x16x32_bf16 v[156:159], a[116:119], v[128:131], v[156:159]
    ds_read_b64_tr_b16 a[184:185], v15 offset:51200
    v_mfma_f32_16x16x32_bf16 v[176:179], v[128:131], a[180:183], v[176:179]
    ds_read_b64_tr_b16 a[186:187], v15 offset:51712
    v_mfma_f32_16x16x32_bf16 v[196:199], a[52:55], v[128:131], v[196:199]
    ds_read_b64_tr_b16 a[56:57], v15 offset:49152
    v_mfma_f32_16x16x32_bf16 v[160:163], a[116:119], v[132:135], v[160:163]
    ds_read_b64_tr_b16 a[58:59], v15 offset:49664
    v_mfma_f32_16x16x32_bf16 v[180:183], v[132:135], a[180:183], v[180:183]
    ds_read_b128 v[76:79], v7 offset:32768
    v_mfma_f32_16x16x32_bf16 v[200:203], a[52:55], v[132:135], v[200:203]
    ds_read_b128 v[80:83], v7 offset:34816
    v_mfma_f32_16x16x32_bf16 v[164:167], a[116:119], v[136:139], v[164:167]
    ds_read_b128 v[84:87], v7 offset:36864
    v_mfma_f32_16x16x32_bf16 v[184:187], v[136:139], a[180:183], v[184:187]
    ds_read_b128 v[120:123], v7 offset:38912
    v_mfma_f32_16x16x32_bf16 v[204:207], a[52:55], v[136:139], v[204:207]
    v_mfma_f32_16x16x32_bf16 v[168:171], a[116:119], v[140:143], v[168:171]
    v_mfma_f32_16x16x32_bf16 v[188:191], v[140:143], a[180:183], v[188:191]
    v_mfma_f32_16x16x32_bf16 v[208:211], a[52:55], v[140:143], v[208:211]
    s_waitcnt lgkmcnt(0)
    v_xor_b32 v105, 32, v29
    v_xor_b32 v106, 64, v29
    v_xor_b32 v107, 96, v29
    v_mfma_f32_16x16x32_bf16 v[152:155], a[120:123], v[72:75], v[152:155]
    ds_read_b64_tr_b16 a[124:125], v15 offset:62464
    v_mfma_f32_16x16x32_bf16 v[172:175], v[72:75], a[184:187], v[172:175]
    ds_read_b64_tr_b16 a[126:127], v15 offset:62976
    v_mfma_f32_16x16x32_bf16 v[192:195], a[56:59], v[72:75], v[192:195]
    ds_read_b128 v[124:127], v8 offset:30720
    v_mfma_f32_16x16x32_bf16 v[156:159], a[120:123], v[76:79], v[156:159]
    ds_read_b64_tr_b16 a[188:189], v15 offset:63488
    v_mfma_f32_16x16x32_bf16 v[176:179], v[76:79], a[184:187], v[176:179]
    ds_read_b64_tr_b16 a[190:191], v15 offset:64000
    v_mfma_f32_16x16x32_bf16 v[196:199], a[56:59], v[76:79], v[196:199]
    ds_read_b64_tr_b16 a[60:61], v15 offset:61440
    v_mfma_f32_16x16x32_bf16 v[160:163], a[120:123], v[80:83], v[160:163]
    ds_read_b64_tr_b16 a[62:63], v15 offset:61952
    v_mfma_f32_16x16x32_bf16 v[180:183], v[80:83], a[184:187], v[180:183]
    ds_read_b128 v[128:131], v8 offset:32768
    v_mfma_f32_16x16x32_bf16 v[200:203], a[56:59], v[80:83], v[200:203]
    ds_read_b128 v[132:135], v8 offset:34816
    v_mfma_f32_16x16x32_bf16 v[164:167], a[120:123], v[84:87], v[164:167]
    ds_read_b128 v[136:139], v8 offset:36864
    v_mfma_f32_16x16x32_bf16 v[184:187], v[84:87], a[184:187], v[184:187]
    ds_read_b128 v[140:143], v8 offset:38912
    v_mfma_f32_16x16x32_bf16 v[204:207], a[56:59], v[84:87], v[204:207]
    ds_read_b64 v[56:57], v29 offset:0
    v_mfma_f32_16x16x32_bf16 v[168:171], a[120:123], v[120:123], v[168:171]
    ds_read_b64 v[58:59], v105 offset:0
    v_mfma_f32_16x16x32_bf16 v[188:191], v[120:123], a[184:187], v[188:191]
    ds_read_b64 v[60:61], v106 offset:0
    v_mfma_f32_16x16x32_bf16 v[208:211], a[56:59], v[120:123], v[208:211]
    ds_read_b64 v[62:63], v107 offset:0
    s_waitcnt lgkmcnt(0)
    s_barrier
    v_mfma_f32_16x16x32_bf16 v[152:155], a[124:127], v[124:127], v[152:155]
    ds_read2_b32 v[144:145], v13 offset0:0 offset1:80
    s_add_u32 m0, s77, 106496
    v_mfma_f32_16x16x32_bf16 v[172:175], v[124:127], a[188:191], v[172:175]
    s_mov_b32 s78, 196608
    buffer_load_dwordx4 v31, s[16:19], s78 offen lds
    v_mfma_f32_16x16x32_bf16 v[192:195], a[60:63], v[124:127], v[192:195]
    ds_read_b128 v[212:215], v14 offset:0
    s_add_u32 m0, s77, 110592
    v_mfma_f32_16x16x32_bf16 v[156:159], a[124:127], v[128:131], v[156:159]
    ds_read_b128 v[216:219], v14 offset:320
    s_mov_b32 s78, 229376
    v_mfma_f32_16x16x32_bf16 v[176:179], v[128:131], a[188:191], v[176:179]
    buffer_load_dwordx4 v31, s[16:19], s78 offen lds
    v_mfma_f32_16x16x32_bf16 v[196:199], a[60:63], v[128:131], v[196:199]
    ds_read2_b32 v[148:149], v13 offset0:16 offset1:96
    s_add_u32 m0, s77, 114688
    v_mfma_f32_16x16x32_bf16 v[160:163], a[124:127], v[132:135], v[160:163]
    ds_read_b128 v[220:223], v14 offset:64
    s_mov_b32 s78, 262144
    v_mfma_f32_16x16x32_bf16 v[180:183], v[132:135], a[188:191], v[180:183]
    buffer_load_dwordx4 v31, s[16:19], s78 offen lds
    v_mfma_f32_16x16x32_bf16 v[200:203], a[60:63], v[132:135], v[200:203]
    ds_read_b128 v[224:227], v14 offset:384
    s_add_u32 m0, s77, 118784
    v_mfma_f32_16x16x32_bf16 v[164:167], a[124:127], v[136:139], v[164:167]
    ds_read2_b32 v[150:151], v13 offset0:32 offset1:112
    s_mov_b32 s78, 294912
    v_mfma_f32_16x16x32_bf16 v[184:187], v[136:139], a[188:191], v[184:187]
    buffer_load_dwordx4 v31, s[16:19], s78 offen lds
    v_mfma_f32_16x16x32_bf16 v[204:207], a[60:63], v[136:139], v[204:207]
    ds_read_b128 v[228:231], v14 offset:128
    s_add_u32 m0, s77, 122880
    v_mfma_f32_16x16x32_bf16 v[168:171], a[124:127], v[140:143], v[168:171]
    ds_read_b128 v[232:235], v14 offset:448
    s_mov_b32 s78, 327680
    v_mfma_f32_16x16x32_bf16 v[188:191], v[140:143], a[188:191], v[188:191]
    buffer_load_dwordx4 v31, s[16:19], s78 offen lds
    v_mfma_f32_16x16x32_bf16 v[208:211], a[60:63], v[140:143], v[208:211]
    ds_read2_b32 v[146:147], v13 offset0:48 offset1:128
    s_add_u32 m0, s77, 126976
    ds_read_b128 v[236:239], v14 offset:192
    ds_read_b128 v[240:243], v14 offset:512
    ds_read2_b32 v[252:253], v13 offset0:64 offset1:144
    ds_read_b128 v[244:247], v14 offset:256
    ds_read_b128 v[248:251], v14 offset:576
    s_mov_b32 s78, 360448
    buffer_load_dwordx4 v31, s[16:19], s78 offen lds
    s_mov_b32 s61, m0
    s_mov_b32 m0, 162816
    s_mov_b64 exec, 0xffff
    buffer_load_dword v95, s[20:23], s94 offen lds
    s_mov_b64 exec, -1
    s_mov_b32 m0, s61
    v_mov_b32 v24, v172
    v_mov_b32 v80, v172
    v_mov_b32_dpp v20, v152 row_newbcast:0 row_mask:0xf bank_mask:0xf
    s_nop 0
    v_permlane16_swap_b32 v24, v80
    v_mov_b32_dpp v21, v153 row_newbcast:0 row_mask:0xf bank_mask:0xf
    v_mov_b32 v80, v24
    v_mov_b32_dpp v22, v154 row_newbcast:0 row_mask:0xf bank_mask:0xf
    v_mov_b32_dpp v23, v155 row_newbcast:0 row_mask:0xf bank_mask:0xf
    v_permlane32_swap_b32 v24, v80
    v_mov_b32_dpp v16, v192 row_newbcast:0 row_mask:0xf bank_mask:0xf
    v_mov_b32_dpp v17, v193 row_newbcast:0 row_mask:0xf bank_mask:0xf
    v_mov_b32_dpp v18, v194 row_newbcast:0 row_mask:0xf bank_mask:0xf
    v_mov_b32_dpp v19, v195 row_newbcast:0 row_mask:0xf bank_mask:0xf
    v_mov_b32 v15, v88
    v_mov_b32 v30, v89
    s_lshl_b32 s59, s45, 7
    s_add_u32 m0, s77, 131072
    s_mov_b32 s78, 393216
    buffer_load_dwordx4 v31, s[16:19], s78 offen lds
    s_waitcnt lgkmcnt(12)
    v_pk_fma_f32 v[152:153], v[20:21], v[144:145], v[152:153] op_sel_hi:[1,0,1] neg_lo:[0,1,0] neg_hi:[0,1,0]
    v_pk_fma_f32 v[154:155], v[22:23], v[144:145], v[154:155] op_sel_hi:[1,0,1] neg_lo:[0,1,0] neg_hi:[0,1,0]
    v_pk_fma_f32 v[172:173], v[212:213], v[24:25], v[172:173] op_sel_hi:[1,0,1] neg_lo:[0,1,0] neg_hi:[0,1,0]
    v_pk_fma_f32 v[174:175], v[214:215], v[24:25], v[174:175] op_sel_hi:[1,0,1] neg_lo:[0,1,0] neg_hi:[0,1,0]
    v_pk_mul_f32 v[152:153], v[152:153], v[144:145] op_sel:[0,1] op_sel_hi:[1,1]
    v_pk_mul_f32 v[154:155], v[154:155], v[144:145] op_sel:[0,1] op_sel_hi:[1,1]
    v_pk_mul_f32 v[172:173], v[172:173], v[216:217]
    v_pk_mul_f32 v[174:175], v[174:175], v[218:219]
    v_cvt_pk_bf16_f32 v128, v152, v153
    v_cvt_pk_bf16_f32 v129, v154, v155
    s_add_u32 m0, s77, 135168
    s_mov_b32 s78, 425984
    buffer_load_dwordx4 v31, s[16:19], s78 offen lds
    v_cvt_pk_bf16_f32 v138, v172, v173
    v_cvt_pk_bf16_f32 v139, v174, v175
    s_waitcnt lgkmcnt(9)
    v_pk_fma_f32 v[156:157], v[20:21], v[148:149], v[156:157] op_sel_hi:[1,0,1] neg_lo:[0,1,0] neg_hi:[0,1,0]
    v_pk_fma_f32 v[158:159], v[22:23], v[148:149], v[158:159] op_sel_hi:[1,0,1] neg_lo:[0,1,0] neg_hi:[0,1,0]
    v_pk_fma_f32 v[176:177], v[220:221], v[24:25], v[176:177] op_sel_hi:[1,0,1] neg_lo:[0,1,0] neg_hi:[0,1,0]
    v_pk_fma_f32 v[178:179], v[222:223], v[24:25], v[178:179] op_sel_hi:[1,0,1] neg_lo:[0,1,0] neg_hi:[0,1,0]
    v_pk_fma_f32 v[196:197], v[16:17], v[148:149], v[196:197] op_sel_hi:[1,0,1] neg_lo:[0,1,0] neg_hi:[0,1,0]
    v_pk_fma_f32 v[198:199], v[18:19], v[148:149], v[198:199] op_sel_hi:[1,0,1] neg_lo:[0,1,0] neg_hi:[0,1,0]
    v_pk_mul_f32 v[156:157], v[156:157], v[148:149] op_sel:[0,1] op_sel_hi:[1,1]
    v_pk_mul_f32 v[158:159], v[158:159], v[148:149] op_sel:[0,1] op_sel_hi:[1,1]
    s_add_u32 m0, s77, 139264
    s_mov_b32 s78, 458752
    buffer_load_dwordx4 v31, s[16:19], s78 offen lds
    v_pk_mul_f32 v[176:177], v[176:177], v[224:225]
    v_pk_mul_f32 v[178:179], v[178:179], v[226:227]
    v_mul_f32 v148, s90, v149
    v_cvt_pk_bf16_f32 v120, v196, v197
    v_cvt_pk_bf16_f32 v121, v198, v199
    v_cvt_pk_bf16_f32 v130, v156, v157
    v_cvt_pk_bf16_f32 v131, v158, v159
    v_cvt_pk_bf16_f32 v140, v176, v177
    v_cvt_pk_bf16_f32 v141, v178, v179
    s_waitcnt lgkmcnt(6)
    v_pk_fma_f32 v[160:161], v[20:21], v[150:151], v[160:161] op_sel_hi:[1,0,1] neg_lo:[0,1,0] neg_hi:[0,1,0]
    s_add_u32 m0, s77, 143360
    s_mov_b32 s78, 491520
    buffer_load_dwordx4 v31, s[16:19], s78 offen lds
    v_pk_fma_f32 v[162:163], v[22:23], v[150:151], v[162:163] op_sel_hi:[1,0,1] neg_lo:[0,1,0] neg_hi:[0,1,0]
    v_pk_fma_f32 v[180:181], v[228:229], v[24:25], v[180:181] op_sel_hi:[1,0,1] neg_lo:[0,1,0] neg_hi:[0,1,0]
    v_pk_fma_f32 v[182:183], v[230:231], v[24:25], v[182:183] op_sel_hi:[1,0,1] neg_lo:[0,1,0] neg_hi:[0,1,0]
    v_pk_fma_f32 v[200:201], v[16:17], v[150:151], v[200:201] op_sel_hi:[1,0,1] neg_lo:[0,1,0] neg_hi:[0,1,0]
    v_pk_fma_f32 v[202:203], v[18:19], v[150:151], v[202:203] op_sel_hi:[1,0,1] neg_lo:[0,1,0] neg_hi:[0,1,0]
    v_pk_mul_f32 v[160:161], v[160:161], v[150:151] op_sel:[0,1] op_sel_hi:[1,1]
    v_pk_mul_f32 v[162:163], v[162:163], v[150:151] op_sel:[0,1] op_sel_hi:[1,1]
    v_pk_mul_f32 v[180:181], v[180:181], v[232:233]
    v_pk_mul_f32 v[182:183], v[182:183], v[234:235]
    v_mul_f32 v149, s90, v151
    buffer_load_dwordx2 v[48:49], v92, s[40:43], s59 offen offset:0
    v_cvt_pk_bf16_f32 v122, v200, v201
    v_cvt_pk_bf16_f32 v123, v202, v203
    v_cvt_pk_bf16_f32 v132, v160, v161
    v_cvt_pk_bf16_f32 v133, v162, v163
    v_cvt_pk_bf16_f32 v142, v180, v181
    v_cvt_pk_bf16_f32 v143, v182, v183
    s_waitcnt lgkmcnt(3)
    v_pk_fma_f32 v[164:165], v[20:21], v[146:147], v[164:165] op_sel_hi:[1,0,1] neg_lo:[0,1,0] neg_hi:[0,1,0]
    v_pk_fma_f32 v[166:167], v[22:23], v[146:147], v[166:167] op_sel_hi:[1,0,1] neg_lo:[0,1,0] neg_hi:[0,1,0]
    v_pk_fma_f32 v[184:185], v[236:237], v[24:25], v[184:185] op_sel_hi:[1,0,1] neg_lo:[0,1,0] neg_hi:[0,1,0]
    v_pk_fma_f32 v[186:187], v[238:239], v[24:25], v[186:187] op_sel_hi:[1,0,1] neg_lo:[0,1,0] neg_hi:[0,1,0]
    buffer_load_dwordx2 v[50:51], v92, s[40:43], s59 offen offset:32
    v_pk_fma_f32 v[204:205], v[16:17], v[146:147], v[204:205] op_sel_hi:[1,0,1] neg_lo:[0,1,0] neg_hi:[0,1,0]
    v_pk_fma_f32 v[206:207], v[18:19], v[146:147], v[206:207] op_sel_hi:[1,0,1] neg_lo:[0,1,0] neg_hi:[0,1,0]
    v_pk_mul_f32 v[164:165], v[164:165], v[146:147] op_sel:[0,1] op_sel_hi:[1,1]
    v_pk_mul_f32 v[166:167], v[166:167], v[146:147] op_sel:[0,1] op_sel_hi:[1,1]
    v_pk_mul_f32 v[184:185], v[184:185], v[240:241]
    v_pk_mul_f32 v[186:187], v[186:187], v[242:243]
    v_mul_f32 v150, s90, v147
    v_cvt_pk_bf16_f32 v124, v204, v205
    v_cvt_pk_bf16_f32 v125, v206, v207
    v_cvt_pk_bf16_f32 v134, v164, v165
    buffer_load_dwordx2 v[52:53], v92, s[40:43], s59 offen offset:64
    v_cvt_pk_bf16_f32 v135, v166, v167
    v_cvt_pk_bf16_f32 v144, v184, v185
    v_cvt_pk_bf16_f32 v145, v186, v187
    s_waitcnt lgkmcnt(0)
    v_pk_fma_f32 v[168:169], v[20:21], v[252:253], v[168:169] op_sel_hi:[1,0,1] neg_lo:[0,1,0] neg_hi:[0,1,0]
    v_pk_fma_f32 v[170:171], v[22:23], v[252:253], v[170:171] op_sel_hi:[1,0,1] neg_lo:[0,1,0] neg_hi:[0,1,0]
    v_pk_fma_f32 v[188:189], v[244:245], v[24:25], v[188:189] op_sel_hi:[1,0,1] neg_lo:[0,1,0] neg_hi:[0,1,0]
    v_pk_fma_f32 v[190:191], v[246:247], v[24:25], v[190:191] op_sel_hi:[1,0,1] neg_lo:[0,1,0] neg_hi:[0,1,0]
    v_pk_fma_f32 v[208:209], v[16:17], v[252:253], v[208:209] op_sel_hi:[1,0,1] neg_lo:[0,1,0] neg_hi:[0,1,0]
    v_pk_fma_f32 v[210:211], v[18:19], v[252:253], v[210:211] op_sel_hi:[1,0,1] neg_lo:[0,1,0] neg_hi:[0,1,0]
    v_pk_mul_f32 v[168:169], v[168:169], v[252:253] op_sel:[0,1] op_sel_hi:[1,1]
    buffer_load_dwordx2 v[54:55], v92, s[40:43], s59 offen offset:96
    v_pk_mul_f32 v[170:171], v[170:171], v[252:253] op_sel:[0,1] op_sel_hi:[1,1]
    v_pk_mul_f32 v[188:189], v[188:189], v[248:249]
    v_pk_mul_f32 v[190:191], v[190:191], v[250:251]
    v_mul_f32 v151, s90, v253
    v_cvt_pk_bf16_f32 v126, v208, v209
    v_cvt_pk_bf16_f32 v127, v210, v211
    v_cvt_pk_bf16_f32 v136, v168, v169
    v_cvt_pk_bf16_f32 v137, v170, v171
    v_cvt_pk_bf16_f32 v146, v188, v189
    v_cvt_pk_bf16_f32 v147, v190, v191
    buffer_load_dwordx4 v[116:119], v3, s[40:43], 0 offen
    s_mov_b32 s10, 0
    v_mov_b32 v31, v91
    v_subrev_u32 v114, s49, v113
    v_cmp_le_u32 vcc, 16, v114
    s_cbranch_vccnz L_XRETRY
L_XOK:
    v_cmp_ne_u32 vcc, s51, v113
    s_nop 0
    s_cmp_eq_u64 vcc, 0
    s_cselect_b32 s51, 1, 0
    s_mov_b32 s77, s51
L_ATT:
    v_mfma_f32_16x16x16_bf16 v[152:155], v[130:131], v[120:121], v[32:35]
    v_mfma_f32_16x16x16_bf16 v[156:159], v[128:129], v[120:121], v[40:43]
    v_mfma_f32_16x16x16_bf16 v[160:163], v[132:133], v[122:123], v[32:35]
    v_mfma_f32_16x16x16_bf16 v[164:167], v[130:131], v[122:123], v[36:39]
    v_mfma_f32_16x16x16_bf16 v[168:171], v[134:135], v[124:125], v[32:35]
    v_mfma_f32_16x16x16_bf16 v[172:175], v[132:133], v[124:125], v[36:39]
    v_mfma_f32_16x16x16_bf16 v[176:179], v[136:137], v[126:127], v[32:35]
    v_mfma_f32_16x16x16_bf16 v[180:183], v[134:135], v[126:127], v[36:39]
    s_add_u32 s58, s94, 32768
    s_nop 0
    v_max_f32 v152, v152, v156
    v_max_f32 v153, v153, v157
    v_max_f32 v154, v154, v158
    v_max_f32 v155, v155, v159
    v_max3_f32 v185, v152, v153, v154
    v_max_f32 v185, v185, v155
    v_max_f32 v160, v160, v164
    v_max_f32 v161, v161, v165
    v_max_f32 v162, v162, v166
    v_max_f32 v163, v163, v167
    v_max3_f32 v187, v160, v161, v162
    v_max_f32 v187, v187, v163
    v_max_f32 v168, v168, v172
    v_max_f32 v169, v169, v173
    v_max_f32 v170, v170, v174
    v_max_f32 v171, v171, v175
    v_max3_f32 v189, v168, v169, v170
    v_max_f32 v189, v189, v171
    v_max_f32 v176, v176, v180
    v_max_f32 v177, v177, v181
    v_max_f32 v178, v178, v182
    v_max_f32 v179, v179, v183
    v_max3_f32 v191, v176, v177, v178
    v_max_f32 v191, v191, v179
    v_mov_b32 v184, v148
    v_permlane32_swap_b32 v185, v187
    v_permlane32_swap_b32 v189, v191
    v_max_f32 v185, v185, v187
    v_max_f32 v189, v189, v191
    v_mov_b32 v186, v149
    v_mov_b32 v188, v150
    v_permlane16_swap_b32 v185, v189
    v_max_f32 v185, v185, v189
    v_mov_b32 v189, v185
    v_mov_b32 v190, v151
    s_nop 0
    v_permlane16_swap_b32 v185, v189
    v_mov_b32 v187, v185
    v_mov_b32 v191, v189
    s_nop 0
    v_permlane32_swap_b32 v185, v187
    v_permlane32_swap_b32 v189, v191
    v_mul_f32 v185, v185, v184
    v_mul_f32 v187, v187, v186
    v_mul_f32 v189, v189, v188
    v_mul_f32 v191, v191, v190
    v_pk_fma_f32 v[152:153], v[152:153], v[184:185], v[184:185] op_sel:[0,0,1] op_sel_hi:[1,0,1] neg_lo:[0,0,1] neg_hi:[0,0,1]
    v_pk_fma_f32 v[154:155], v[154:155], v[184:185], v[184:185] op_sel:[0,0,1] op_sel_hi:[1,0,1] neg_lo:[0,0,1] neg_hi:[0,0,1]
    v_exp_f32 v152, v152
    v_exp_f32 v153, v153
    v_exp_f32 v154, v154
    v_exp_f32 v155, v155
    v_pk_fma_f32 v[160:161], v[160:161], v[186:187], v[186:187] op_sel:[0,0,1] op_sel_hi:[1,0,1] neg_lo:[0,0,1] neg_hi:[0,0,1]
    v_pk_fma_f32 v[162:163], v[162:163], v[186:187], v[186:187] op_sel:[0,0,1] op_sel_hi:[1,0,1] neg_lo:[0,0,1] neg_hi:[0,0,1]
    v_exp_f32 v160, v160
    v_exp_f32 v161, v161
    v_exp_f32 v162, v162
    v_exp_f32 v163, v163
    v_pk_fma_f32 v[168:169], v[168:169], v[188:189], v[188:189] op_sel:[0,0,1] op_sel_hi:[1,0,1] neg_lo:[0,0,1] neg_hi:[0,0,1]
    v_pk_fma_f32 v[170:171], v[170:171], v[188:189], v[188:189] op_sel:[0,0,1] op_sel_hi:[1,0,1] neg_lo:[0,0,1] neg_hi:[0,0,1]
    v_exp_f32 v168, v168
    v_exp_f32 v169, v169
    v_exp_f32 v170, v170
    v_exp_f32 v171, v171
    v_pk_fma_f32 v[176:177], v[176:177], v[190:191], v[190:191] op_sel:[0,0,1] op_sel_hi:[1,0,1] neg_lo:[0,0,1] neg_hi:[0,0,1]
    v_pk_fma_f32 v[178:179], v[178:179], v[190:191], v[190:191] op_sel:[0,0,1] op_sel_hi:[1,0,1] neg_lo:[0,0,1] neg_hi:[0,0,1]
    v_exp_f32 v176, v176
    v_exp_f32 v177, v177
    v_exp_f32 v178, v178
    v_exp_f32 v179, v179
    v_cvt_pk_bf16_f32 v192, v152, v153
    v_cvt_pk_bf16_f32 v193, v154, v155
    v_and_b32 v196, v192, v26
    v_and_b32 v197, v193, v27
    v_mfma_f32_16x16x16_bf16 v[216:219], v[44:45], v[192:193], 0
    v_xor_b32 v194, v192, v196
    v_xor_b32 v195, v193, v197
    v_cvt_pk_bf16_f32 v198, v160, v161
    v_cvt_pk_bf16_f32 v199, v162, v163
    v_mfma_f32_16x16x32_bf16 v[232:235], v[138:141], v[194:197], 0
    v_and_b32 v202, v198, v26
    v_and_b32 v203, v199, v27
    v_mfma_f32_16x16x16_bf16 v[220:223], v[44:45], v[198:199], 0
    v_xor_b32 v200, v198, v202
    v_xor_b32 v201, v199, v203
    v_cvt_pk_bf16_f32 v204, v168, v169
    v_cvt_pk_bf16_f32 v205, v170, v171
    v_mfma_f32_16x16x32_bf16 v[236:239], v[140:143], v[200:203], 0
    v_and_b32 v208, v204, v26
    v_and_b32 v209, v205, v27
    v_mfma_f32_16x16x16_bf16 v[224:227], v[44:45], v[204:205], 0
    v_xor_b32 v206, v204, v208
    v_xor_b32 v207, v205, v209
    v_cvt_pk_bf16_f32 v210, v176, v177
    v_cvt_pk_bf16_f32 v211, v178, v179
    v_mfma_f32_16x16x32_bf16 v[240:243], v[142:145], v[206:209], 0
    v_and_b32 v214, v210, v26
    v_and_b32 v215, v211, v27
    v_mfma_f32_16x16x16_bf16 v[228:231], v[44:45], v[210:211], 0
    v_xor_b32 v212, v210, v214
    v_xor_b32 v213, v211, v215
    v_mov_b32 v248, s49
    s_nop 0
    v_mfma_f32_16x16x32_bf16 v[244:247], v[144:147], v[212:215], 0
    v_rcp_f32 v216, v216
    v_rcp_f32 v220, v220
    v_pk_mul_f32 v[232:233], v[232:233], v[216:217] op_sel_hi:[1,0]
    v_pk_mul_f32 v[234:235], v[234:235], v[216:217] op_sel_hi:[1,0]
    v_cvt_pk_bf16_f32 v152, v232, v233
    v_cvt_pk_bf16_f32 v153, v234, v235
    v_rcp_f32 v224, v224
    v_pk_mul_f32 v[236:237], v[236:237], v[220:221] op_sel_hi:[1,0]
    v_pk_mul_f32 v[238:239], v[238:239], v[220:221] op_sel_hi:[1,0]
    v_cvt_pk_bf16_f32 v154, v236, v237
    v_cvt_pk_bf16_f32 v155, v238, v239
    v_rcp_f32 v228, v228
    v_pk_mul_f32 v[240:241], v[240:241], v[224:225] op_sel_hi:[1,0]
    v_pk_mul_f32 v[242:243], v[242:243], v[224:225] op_sel_hi:[1,0]
    v_cvt_pk_bf16_f32 v156, v240, v241
    v_cvt_pk_bf16_f32 v157, v242, v243
    v_permlane16_swap_b32 v152, v154
    v_permlane16_swap_b32 v153, v155
    v_pk_mul_f32 v[244:245], v[244:245], v[228:229] op_sel_hi:[1,0]
    v_pk_mul_f32 v[246:247], v[246:247], v[228:229] op_sel_hi:[1,0]
    v_cvt_pk_bf16_f32 v158, v244, v245
    v_cvt_pk_bf16_f32 v159, v246, v247
    s_nop 0
    v_permlane16_swap_b32 v156, v158
    v_permlane16_swap_b32 v157, v159
    s_cmp_eq_u32 s77, 0
    s_cbranch_scc1 LS_12
    buffer_store_dwordx4 v[152:155], v15, s[20:23], s94 offen
    buffer_store_dwordx4 v[156:159], v15, s[20:23], s58 offen
    s_branch LS_13
LS_12:
    buffer_store_dwordx4 v[152:155], v15, s[20:23], s94 offen sc1
    buffer_store_dwordx4 v[156:159], v15, s[20:23], s58 offen sc1
LS_13:
L_ATTE:
    s_and_b32 s59, s96, 0xffffff80
    s_mov_b32 s57, s95
    s_cmp_lg_u32 s53, 0
    s_cbranch_scc1 LO_14
    s_waitcnt vmcnt(2)
    s_barrier
    s_cmp_lg_u32 s85, 0
    s_cbranch_scc1 LO_15
    s_mul_i32 s73, s44, 20480
    s_mul_i32 s75, s44, 458752
    s_lshl_b32 s56, s54, 6
    s_add_u32 s75, s75, s56
    s_add_u32 m0, s73, 1024
    s_add_u32 s78, s75, 0
    buffer_load_dwordx4 v90, s[28:31], s78 offen lds
    v_and_b32 v71, 0xffff0000, v63
    v_lshlrev_b32 v70, 16, v63
    v_and_b32 v69, 0xffff0000, v62
    v_lshlrev_b32 v68, 16, v62
    v_and_b32 v67, 0xffff0000, v61
    v_lshlrev_b32 v66, 16, v61
    v_and_b32 v65, 0xffff0000, v60
    v_lshlrev_b32 v64, 16, v60
    v_and_b32 v63, 0xffff0000, v59
    v_lshlrev_b32 v62, 16, v59
    s_add_u32 m0, s73, 2048
    s_add_u32 s78, s75, 57344
    buffer_load_dwordx4 v90, s[28:31], s78 offen lds
    v_and_b32 v61, 0xffff0000, v58
    v_lshlrev_b32 v60, 16, v58
    v_and_b32 v59, 0xffff0000, v57
    v_lshlrev_b32 v58, 16, v57
    v_and_b32 v57, 0xffff0000, v56
    v_lshlrev_b32 v56, 16, v56
    v_mov_b32 v25, 0
    v_dot2c_f32_bf16 v25, v116, v44
    v_dot2c_f32_bf16 v25, v117, v44
    v_dot2c_f32_bf16 v25, v118, v44
    s_add_u32 m0, s73, 3072
    s_add_u32 s78, s75, 114688
    buffer_load_dwordx4 v90, s[28:31], s78 offen lds
    v_dot2c_f32_bf16 v25, v119, v44
    v_and_b32 v160, 3, v1
    v_cmp_eq_u32 vcc, 0, v160
    s_nop 0
    v_add_f32_dpp v25, v25, v25 row_ror:8 row_mask:0xf bank_mask:0xf
    v_cndmask_b32 v48, 0, v48, s[66:67]
    v_cndmask_b32 v48, v48, v44, vcc
    v_cndmask_b32 v49, 0, v49, s[66:67]
    v_cndmask_b32 v49, v49, v44, vcc
    v_add_f32_dpp v25, v25, v25 row_ror:4 row_mask:0xf bank_mask:0xf
    v_cndmask_b32 v50, 0, v50, s[66:67]
    s_add_u32 m0, s73, 4096
    s_add_u32 s78, s75, 172032
    buffer_load_dwordx4 v90, s[28:31], s78 offen lds
    v_cndmask_b32 v50, v50, v44, vcc
    v_cndmask_b32 v51, 0, v51, s[66:67]
    v_cndmask_b32 v51, v51, v44, vcc
    v_add_f32_dpp v25, v25, v25 row_ror:2 row_mask:0xf bank_mask:0xf
    v_cndmask_b32 v52, 0, v52, s[66:67]
    v_cndmask_b32 v52, v52, v44, vcc
    v_cndmask_b32 v53, 0, v53, s[66:67]
    v_cndmask_b32 v53, v53, v44, vcc
    v_add_f32_dpp v25, v25, v25 row_ror:1 row_mask:0xf bank_mask:0xf
    v_cndmask_b32 v54, 0, v54, s[66:67]
    s_add_u32 m0, s73, 5120
    s_add_u32 s78, s75, 229376
    buffer_load_dwordx4 v90, s[28:31], s78 offen lds
    v_cndmask_b32 v54, v54, v44, vcc
    v_cndmask_b32 v55, 0, v55, s[66:67]
    v_cndmask_b32 v55, v55, v44, vcc
    v_mov_b32 v160, v25
    s_nop 1
    v_permlane32_swap_b32 v25, v160
    v_add_f32 v25, v25, v160
    v_mov_b32 v160, v25
    s_nop 1
    v_permlane16_swap_b32 v25, v160
    v_add_f32 v25, v25, v160
    s_add_u32 m0, s73, 6144
    s_add_u32 s78, s75, 286720
    buffer_load_dwordx4 v90, s[28:31], s78 offen lds
    s_add_u32 m0, s73, 7168
    s_add_u32 s78, s75, 344064
    buffer_load_dwordx4 v90, s[28:31], s78 offen lds
    s_add_u32 m0, s73, 8192
    s_add_u32 s78, s75, 401408
    buffer_load_dwordx4 v90, s[28:31], s78 offen lds
    s_waitcnt vmcnt(8)
    s_mov_b64 exec, 1
    s_cmp_eq_u32 s51, 0
    s_cbranch_scc1 LS_17
    buffer_store_dword v248, off, s[20:23], s96
LS_18:
    s_mov_b64 exec, -1
    s_add_u32 m0, s73, 11264
    s_add_u32 s78, s75, 0
    buffer_load_dwordx4 v90, s[32:35], s78 offen lds
    ds_read_b64_tr_b16 v[120:121], v9 offset:0
    ds_read_b64_tr_b16 v[122:123], v9 offset:512
    ds_read_b64_tr_b16 v[124:125], v10 offset:0
    ds_read_b64_tr_b16 v[126:127], v10 offset:512
    s_add_u32 m0, s73, 12288
    s_add_u32 s78, s75, 57344
    buffer_load_dwordx4 v90, s[32:35], s78 offen lds
    ds_read_b64_tr_b16 v[128:129], v11 offset:0
    ds_read_b64_tr_b16 v[130:131], v11 offset:512
    ds_read_b64_tr_b16 v[132:133], v12 offset:0
    ds_read_b64_tr_b16 v[134:135], v12 offset:512
    s_add_u32 m0, s73, 13312
    s_add_u32 s78, s75, 114688
    buffer_load_dwordx4 v90, s[32:35], s78 offen lds
    ds_read_b64_tr_b16 v[136:137], v9 offset:4096
    ds_read_b64_tr_b16 v[138:139], v9 offset:4608
    ds_read_b64_tr_b16 v[140:141], v10 offset:4096
    ds_read_b64_tr_b16 v[142:143], v10 offset:4608
    s_add_u32 m0, s73, 14336
    s_add_u32 s78, s75, 172032
    buffer_load_dwordx4 v90, s[32:35], s78 offen lds
    ds_read_b64_tr_b16 v[144:145], v11 offset:4096
    ds_read_b64_tr_b16 v[146:147], v11 offset:4608
    ds_read_b64_tr_b16 v[148:149], v12 offset:4096
    ds_read_b64_tr_b16 v[150:151], v12 offset:4608
    s_add_u32 m0, s73, 15360
    s_add_u32 s78, s75, 229376
    buffer_load_dwordx4 v90, s[32:35], s78 offen lds
    ds_read_b64_tr_b16 v[72:73], v9 offset:8192
    ds_read_b64_tr_b16 v[74:75], v9 offset:8704
    ds_read_b64_tr_b16 v[76:77], v10 offset:8192
    ds_read_b64_tr_b16 v[78:79], v10 offset:8704
    s_add_u32 m0, s73, 16384
    s_add_u32 s78, s75, 286720
    buffer_load_dwordx4 v90, s[32:35], s78 offen lds
    ds_read_b64_tr_b16 v[80:81], v11 offset:8192
    ds_read_b64_tr_b16 v[82:83], v11 offset:8704
    ds_read_b64_tr_b16 v[84:85], v12 offset:8192
    ds_read_b64_tr_b16 v[86:87], v12 offset:8704
    s_add_u32 m0, s73, 17408
    s_add_u32 s78, s75, 344064
    buffer_load_dwordx4 v90, s[32:35], s78 offen lds
    ds_read_b64_tr_b16 v[232:233], v9 offset:12288
    ds_read_b64_tr_b16 v[234:235], v9 offset:12800
    ds_read_b64_tr_b16 v[236:237], v10 offset:12288
    ds_read_b64_tr_b16 v[238:239], v10 offset:12800
    s_add_u32 m0, s73, 18432
    s_add_u32 s78, s75, 401408
    buffer_load_dwordx4 v90, s[32:35], s78 offen lds
    ds_read_b64_tr_b16 v[240:241], v11 offset:12288
    ds_read_b64_tr_b16 v[242:243], v11 offset:12800
    ds_read_b64_tr_b16 v[244:245], v12 offset:12288
    ds_read_b64_tr_b16 v[246:247], v12 offset:12800
    s_branch LO_16
LO_15:
    v_and_b32 v71, 0xffff0000, v63
    v_lshlrev_b32 v70, 16, v63
    v_and_b32 v69, 0xffff0000, v62
    v_lshlrev_b32 v68, 16, v62
    v_and_b32 v67, 0xffff0000, v61
    v_lshlrev_b32 v66, 16, v61
    v_and_b32 v65, 0xffff0000, v60
    v_lshlrev_b32 v64, 16, v60
    v_and_b32 v63, 0xffff0000, v59
    v_lshlrev_b32 v62, 16, v59
    v_and_b32 v61, 0xffff0000, v58
    v_lshlrev_b32 v60, 16, v58
    v_and_b32 v59, 0xffff0000, v57
    v_lshlrev_b32 v58, 16, v57
    v_and_b32 v57, 0xffff0000, v56
    v_lshlrev_b32 v56, 16, v56
    v_mov_b32 v25, 0
    v_dot2c_f32_bf16 v25, v116, v44
    v_dot2c_f32_bf16 v25, v117, v44
    v_dot2c_f32_bf16 v25, v118, v44
    v_dot2c_f32_bf16 v25, v119, v44
    v_and_b32 v160, 3, v1
    v_cmp_eq_u32 vcc, 0, v160
    s_nop 0
    v_add_f32_dpp v25, v25, v25 row_ror:8 row_mask:0xf bank_mask:0xf
    v_cndmask_b32 v48, 0, v48, s[66:67]
    v_cndmask_b32 v48, v48, v44, vcc
    v_cndmask_b32 v49, 0, v49, s[66:67]
    v_cndmask_b32 v49, v49, v44, vcc
    v_add_f32_dpp v25, v25, v25 row_ror:4 row_mask:0xf bank_mask:0xf
    v_cndmask_b32 v50, 0, v50, s[66:67]
    v_cndmask_b32 v50, v50, v44, vcc
    v_cndmask_b32 v51, 0, v51, s[66:67]
    v_cndmask_b32 v51, v51, v44, vcc
    v_add_f32_dpp v25, v25, v25 row_ror:2 row_mask:0xf bank_mask:0xf
    v_cndmask_b32 v52, 0, v52, s[66:67]
    v_cndmask_b32 v52, v52, v44, vcc
    v_cndmask_b32 v53, 0, v53, s[66:67]
    v_cndmask_b32 v53, v53, v44, vcc
    v_add_f32_dpp v25, v25, v25 row_ror:1 row_mask:0xf bank_mask:0xf
    v_cndmask_b32 v54, 0, v54, s[66:67]
    v_cndmask_b32 v54, v54, v44, vcc
    v_cndmask_b32 v55, 0, v55, s[66:67]
    v_cndmask_b32 v55, v55, v44, vcc
    v_mov_b32 v160, v25
    s_nop 1
    v_permlane32_swap_b32 v25, v160
    v_add_f32 v25, v25, v160
    v_mov_b32 v160, v25
    s_nop 1
    v_permlane16_swap_b32 v25, v160
    v_add_f32 v25, v25, v160
LO_14:
    ds_read_b64_tr_b16 v[120:121], v9 offset:0
    ds_read_b64_tr_b16 v[122:123], v9 offset:512
    ds_read_b64_tr_b16 v[124:125], v10 offset:0
    ds_read_b64_tr_b16 v[126:127], v10 offset:512
    ds_read_b64_tr_b16 v[128:129], v11 offset:0
    ds_read_b64_tr_b16 v[130:131], v11 offset:512
    ds_read_b64_tr_b16 v[132:133], v12 offset:0
    ds_read_b64_tr_b16 v[134:135], v12 offset:512
    ds_read_b64_tr_b16 v[136:137], v9 offset:4096
    ds_read_b64_tr_b16 v[138:139], v9 offset:4608
    ds_read_b64_tr_b16 v[140:141], v10 offset:4096
    ds_read_b64_tr_b16 v[142:143], v10 offset:4608
    ds_read_b64_tr_b16 v[144:145], v11 offset:4096
    ds_read_b64_tr_b16 v[146:147], v11 offset:4608
    ds_read_b64_tr_b16 v[148:149], v12 offset:4096
    ds_read_b64_tr_b16 v[150:151], v12 offset:4608
    s_waitcnt vmcnt(0)
    s_mov_b64 exec, 1
    s_cmp_eq_u32 s51, 0
    s_cbranch_scc1 LS_19
    buffer_store_dword v248, off, s[20:23], s96
LS_20:
    s_mov_b64 exec, -1
    ds_read_b64_tr_b16 v[72:73], v9 offset:8192
    ds_read_b64_tr_b16 v[74:75], v9 offset:8704
    ds_read_b64_tr_b16 v[76:77], v10 offset:8192
    ds_read_b64_tr_b16 v[78:79], v10 offset:8704
    ds_read_b64_tr_b16 v[80:81], v11 offset:8192
    ds_read_b64_tr_b16 v[82:83], v11 offset:8704
    ds_read_b64_tr_b16 v[84:85], v12 offset:8192
    ds_read_b64_tr_b16 v[86:87], v12 offset:8704
    ds_read_b64_tr_b16 v[232:233], v9 offset:12288
    ds_read_b64_tr_b16 v[234:235], v9 offset:12800
    ds_read_b64_tr_b16 v[236:237], v10 offset:12288
    ds_read_b64_tr_b16 v[238:239], v10 offset:12800
    ds_read_b64_tr_b16 v[240:241], v11 offset:12288
    ds_read_b64_tr_b16 v[242:243], v11 offset:12800
    ds_read_b64_tr_b16 v[244:245], v12 offset:12288
    ds_read_b64_tr_b16 v[246:247], v12 offset:12800
LO_16:
    s_lshl_b32 s60, s45, 8
    s_add_u32 s60, s60, s97
    v_lshlrev_b32 v248, 4, v1
    buffer_load_dword v249, v30, s[20:23], s59 offen sc1
    s_waitcnt vmcnt(0)
    v_cmp_ne_u32 vcc, s49, v249
    s_cbranch_vccnz LP_22
LP_23:
    buffer_load_dwordx4 v[152:155], v3, s[20:23], s57 offen offset:0 sc1
    buffer_load_dwordx4 v[156:159], v3, s[20:23], s57 offen offset:1024 sc1
    buffer_load_dwordx4 v[160:163], v3, s[20:23], s57 offen offset:2048 sc1
    buffer_load_dwordx4 v[164:167], v3, s[20:23], s57 offen offset:3072 sc1
    s_add_u32 s57, s57, 4096
    buffer_load_dwordx4 v[168:171], v3, s[20:23], s57 offen offset:0 sc1
    buffer_load_dwordx4 v[172:175], v3, s[20:23], s57 offen offset:1024 sc1
    s_waitcnt vmcnt(5) lgkmcnt(0)
    v_mfma_f32_16x16x32_bf16 v[216:219], v[120:123], v[152:155], v[56:59]
    buffer_load_dwordx4 v[176:179], v3, s[20:23], s57 offen offset:2048 sc1
    ds_read_b64_tr_b16 v[120:121], v9 offset:16384
    ds_read_b64_tr_b16 v[122:123], v9 offset:16896
    v_mfma_f32_16x16x32_bf16 v[220:223], v[124:127], v[152:155], v[60:63]
    ds_read_b64_tr_b16 v[124:125], v10 offset:16384
    ds_read_b64_tr_b16 v[126:127], v10 offset:16896
    v_mfma_f32_16x16x32_bf16 v[224:227], v[128:131], v[152:155], v[64:67]
    ds_read_b64_tr_b16 v[128:129], v11 offset:16384
    ds_read_b64_tr_b16 v[130:131], v11 offset:16896
    v_mfma_f32_16x16x32_bf16 v[228:231], v[132:135], v[152:155], v[68:71]
    ds_read_b64_tr_b16 v[132:133], v12 offset:16384
    ds_read_b64_tr_b16 v[134:135], v12 offset:16896
    s_waitcnt vmcnt(5) lgkmcnt(15)
    v_mfma_f32_16x16x32_bf16 v[216:219], v[136:139], v[156:159], v[216:219]
    buffer_load_dwordx4 v[180:183], v3, s[20:23], s57 offen offset:3072 sc1
    ds_read_b64_tr_b16 v[136:137], v9 offset:20480
    ds_read_b64_tr_b16 v[138:139], v9 offset:20992
    v_mfma_f32_16x16x32_bf16 v[220:223], v[140:143], v[156:159], v[220:223]
    ds_read_b64_tr_b16 v[140:141], v10 offset:20480
    ds_read_b64_tr_b16 v[142:143], v10 offset:20992
    v_mfma_f32_16x16x32_bf16 v[224:227], v[144:147], v[156:159], v[224:227]
    ds_read_b64_tr_b16 v[144:145], v11 offset:20480
    ds_read_b64_tr_b16 v[146:147], v11 offset:20992
    v_mfma_f32_16x16x32_bf16 v[228:231], v[148:151], v[156:159], v[228:231]
    ds_read_b64_tr_b16 v[148:149], v12 offset:20480
    ds_read_b64_tr_b16 v[150:151], v12 offset:20992
    s_waitcnt vmcnt(5) lgkmcnt(15)
    v_mfma_f32_16x16x32_bf16 v[216:219], v[72:75], v[160:163], v[216:219]
    s_add_u32 s57, s57, 4096
    buffer_load_dwordx4 v[184:187], v3, s[20:23], s57 offen offset:0 sc1
    ds_read_b64_tr_b16 v[72:73], v9 offset:24576
    ds_read_b64_tr_b16 v[74:75], v9 offset:25088
    v_mfma_f32_16x16x32_bf16 v[220:223], v[76:79], v[160:163], v[220:223]
    ds_read_b64_tr_b16 v[76:77], v10 offset:24576
    ds_read_b64_tr_b16 v[78:79], v10 offset:25088
    v_mfma_f32_16x16x32_bf16 v[224:227], v[80:83], v[160:163], v[224:227]
    ds_read_b64_tr_b16 v[80:81], v11 offset:24576
    ds_read_b64_tr_b16 v[82:83], v11 offset:25088
    v_mfma_f32_16x16x32_bf16 v[228:231], v[84:87], v[160:163], v[228:231]
    ds_read_b64_tr_b16 v[84:85], v12 offset:24576
    ds_read_b64_tr_b16 v[86:87], v12 offset:25088
    s_waitcnt vmcnt(5) lgkmcnt(15)
    v_mfma_f32_16x16x32_bf16 v[216:219], v[232:235], v[164:167], v[216:219]
    buffer_load_dwordx4 v[188:191], v3, s[20:23], s57 offen offset:1024 sc1
    ds_read_b64_tr_b16 v[232:233], v9 offset:28672
    ds_read_b64_tr_b16 v[234:235], v9 offset:29184
    v_mfma_f32_16x16x32_bf16 v[220:223], v[236:239], v[164:167], v[220:223]
    ds_read_b64_tr_b16 v[236:237], v10 offset:28672
    ds_read_b64_tr_b16 v[238:239], v10 offset:29184
    v_mfma_f32_16x16x32_bf16 v[224:227], v[240:243], v[164:167], v[224:227]
    ds_read_b64_tr_b16 v[240:241], v11 offset:28672
    ds_read_b64_tr_b16 v[242:243], v11 offset:29184
    v_mfma_f32_16x16x32_bf16 v[228:231], v[244:247], v[164:167], v[228:231]
    ds_read_b64_tr_b16 v[244:245], v12 offset:28672
    ds_read_b64_tr_b16 v[246:247], v12 offset:29184
    s_waitcnt vmcnt(5) lgkmcnt(15)
    v_mfma_f32_16x16x32_bf16 v[216:219], v[120:123], v[168:171], v[216:219]
    buffer_load_dwordx4 v[192:195], v3, s[20:23], s57 offen offset:2048 sc1
    ds_read_b64_tr_b16 v[120:121], v9 offset:32768
    ds_read_b64_tr_b16 v[122:123], v9 offset:33280
    v_mfma_f32_16x16x32_bf16 v[220:223], v[124:127], v[168:171], v[220:223]
    ds_read_b64_tr_b16 v[124:125], v10 offset:32768
    ds_read_b64_tr_b16 v[126:127], v10 offset:33280
    v_mfma_f32_16x16x32_bf16 v[224:227], v[128:131], v[168:171], v[224:227]
    ds_read_b64_tr_b16 v[128:129], v11 offset:32768
    ds_read_b64_tr_b16 v[130:131], v11 offset:33280
    v_mfma_f32_16x16x32_bf16 v[228:231], v[132:135], v[168:171], v[228:231]
    ds_read_b64_tr_b16 v[132:133], v12 offset:32768
    ds_read_b64_tr_b16 v[134:135], v12 offset:33280
    s_waitcnt vmcnt(5) lgkmcnt(15)
    v_mfma_f32_16x16x32_bf16 v[216:219], v[136:139], v[172:175], v[216:219]
    buffer_load_dwordx4 v[196:199], v3, s[20:23], s57 offen offset:3072 sc1
    ds_read_b64_tr_b16 v[136:137], v9 offset:36864
    ds_read_b64_tr_b16 v[138:139], v9 offset:37376
    v_mfma_f32_16x16x32_bf16 v[220:223], v[140:143], v[172:175], v[220:223]
    ds_read_b64_tr_b16 v[140:141], v10 offset:36864
    ds_read_b64_tr_b16 v[142:143], v10 offset:37376
    v_mfma_f32_16x16x32_bf16 v[224:227], v[144:147], v[172:175], v[224:227]
    ds_read_b64_tr_b16 v[144:145], v11 offset:36864
    ds_read_b64_tr_b16 v[146:147], v11 offset:37376
    v_mfma_f32_16x16x32_bf16 v[228:231], v[148:151], v[172:175], v[228:231]
    ds_read_b64_tr_b16 v[148:149], v12 offset:36864
    ds_read_b64_tr_b16 v[150:151], v12 offset:37376
    s_waitcnt vmcnt(5) lgkmcnt(15)
    v_mfma_f32_16x16x32_bf16 v[216:219], v[72:75], v[176:179], v[216:219]
    s_add_u32 s57, s57, 4096
    buffer_load_dwordx4 v[200:203], v3, s[20:23], s57 offen offset:0 sc1
    ds_read_b64_tr_b16 v[72:73], v9 offset:40960
    ds_read_b64_tr_b16 v[74:75], v9 offset:41472
    v_mfma_f32_16x16x32_bf16 v[220:223], v[76:79], v[176:179], v[220:223]
    ds_read_b64_tr_b16 v[76:77], v10 offset:40960
    ds_read_b64_tr_b16 v[78:79], v10 offset:41472
    v_mfma_f32_16x16x32_bf16 v[224:227], v[80:83], v[176:179], v[224:227]
    ds_read_b64_tr_b16 v[80:81], v11 offset:40960
    ds_read_b64_tr_b16 v[82:83], v11 offset:41472
    v_mfma_f32_16x16x32_bf16 v[228:231], v[84:87], v[176:179], v[228:231]
    ds_read_b64_tr_b16 v[84:85], v12 offset:40960
    ds_read_b64_tr_b16 v[86:87], v12 offset:41472
    s_waitcnt vmcnt(5) lgkmcnt(15)
    v_mfma_f32_16x16x32_bf16 v[216:219], v[232:235], v[180:183], v[216:219]
    buffer_load_dwordx4 v[204:207], v3, s[20:23], s57 offen offset:1024 sc1
    ds_read_b64_tr_b16 v[232:233], v9 offset:45056
    ds_read_b64_tr_b16 v[234:235], v9 offset:45568
    v_mfma_f32_16x16x32_bf16 v[220:223], v[236:239], v[180:183], v[220:223]
    ds_read_b64_tr_b16 v[236:237], v10 offset:45056
    ds_read_b64_tr_b16 v[238:239], v10 offset:45568
    v_mfma_f32_16x16x32_bf16 v[224:227], v[240:243], v[180:183], v[224:227]
    ds_read_b64_tr_b16 v[240:241], v11 offset:45056
    ds_read_b64_tr_b16 v[242:243], v11 offset:45568
    v_mfma_f32_16x16x32_bf16 v[228:231], v[244:247], v[180:183], v[228:231]
    ds_read_b64_tr_b16 v[244:245], v12 offset:45056
    ds_read_b64_tr_b16 v[246:247], v12 offset:45568
    s_waitcnt vmcnt(5) lgkmcnt(15)
    v_mfma_f32_16x16x32_bf16 v[216:219], v[120:123], v[184:187], v[216:219]
    buffer_load_dwordx4 v[208:211], v3, s[20:23], s57 offen offset:2048 sc1
    ds_read_b64_tr_b16 v[120:121], v9 offset:49152
    ds_read_b64_tr_b16 v[122:123], v9 offset:49664
    v_mfma_f32_16x16x32_bf16 v[220:223], v[124:127], v[184:187], v[220:223]
    ds_read_b64_tr_b16 v[124:125], v10 offset:49152
    ds_read_b64_tr_b16 v[126:127], v10 offset:49664
    v_mfma_f32_16x16x32_bf16 v[224:227], v[128:131], v[184:187], v[224:227]
    ds_read_b64_tr_b16 v[128:129], v11 offset:49152
    ds_read_b64_tr_b16 v[130:131], v11 offset:49664
    v_mfma_f32_16x16x32_bf16 v[228:231], v[132:135], v[184:187], v[228:231]
    ds_read_b64_tr_b16 v[132:133], v12 offset:49152
    ds_read_b64_tr_b16 v[134:135], v12 offset:49664
    s_waitcnt vmcnt(5) lgkmcnt(15)
    v_mfma_f32_16x16x32_bf16 v[216:219], v[136:139], v[188:191], v[216:219]
    buffer_load_dwordx4 v[212:215], v3, s[20:23], s57 offen offset:3072 sc1
    ds_read_b64_tr_b16 v[136:137], v9 offset:53248
    ds_read_b64_tr_b16 v[138:139], v9 offset:53760
    v_mfma_f32_16x16x32_bf16 v[220:223], v[140:143], v[188:191], v[220:223]
    ds_read_b64_tr_b16 v[140:141], v10 offset:53248
    ds_read_b64_tr_b16 v[142:143], v10 offset:53760
    v_mfma_f32_16x16x32_bf16 v[224:227], v[144:147], v[188:191], v[224:227]
    ds_read_b64_tr_b16 v[144:145], v11 offset:53248
    ds_read_b64_tr_b16 v[146:147], v11 offset:53760
    v_mfma_f32_16x16x32_bf16 v[228:231], v[148:151], v[188:191], v[228:231]
    ds_read_b64_tr_b16 v[148:149], v12 offset:53248
    ds_read_b64_tr_b16 v[150:151], v12 offset:53760
    s_waitcnt vmcnt(5) lgkmcnt(15)
    v_mfma_f32_16x16x32_bf16 v[216:219], v[72:75], v[192:195], v[216:219]
    ds_read_b64_tr_b16 v[72:73], v9 offset:57344
    ds_read_b64_tr_b16 v[74:75], v9 offset:57856
    v_mfma_f32_16x16x32_bf16 v[220:223], v[76:79], v[192:195], v[220:223]
    ds_read_b64_tr_b16 v[76:77], v10 offset:57344
    ds_read_b64_tr_b16 v[78:79], v10 offset:57856
    v_mfma_f32_16x16x32_bf16 v[224:227], v[80:83], v[192:195], v[224:227]
    ds_read_b64_tr_b16 v[80:81], v11 offset:57344
    ds_read_b64_tr_b16 v[82:83], v11 offset:57856
    v_mfma_f32_16x16x32_bf16 v[228:231], v[84:87], v[192:195], v[228:231]
    ds_read_b64_tr_b16 v[84:85], v12 offset:57344
    ds_read_b64_tr_b16 v[86:87], v12 offset:57856
    s_waitcnt vmcnt(4) lgkmcnt(15)
    v_mfma_f32_16x16x32_bf16 v[216:219], v[232:235], v[196:199], v[216:219]
    ds_read_b64_tr_b16 v[232:233], v9 offset:61440
    ds_read_b64_tr_b16 v[234:235], v9 offset:61952
    v_mfma_f32_16x16x32_bf16 v[220:223], v[236:239], v[196:199], v[220:223]
    ds_read_b64_tr_b16 v[236:237], v10 offset:61440
    ds_read_b64_tr_b16 v[238:239], v10 offset:61952
    v_mfma_f32_16x16x32_bf16 v[224:227], v[240:243], v[196:199], v[224:227]
    ds_read_b64_tr_b16 v[240:241], v11 offset:61440
    ds_read_b64_tr_b16 v[242:243], v11 offset:61952
    v_mfma_f32_16x16x32_bf16 v[228:231], v[244:247], v[196:199], v[228:231]
    ds_read_b64_tr_b16 v[244:245], v12 offset:61440
    ds_read_b64_tr_b16 v[246:247], v12 offset:61952
    s_waitcnt vmcnt(3) lgkmcnt(15)
    v_mfma_f32_16x16x32_bf16 v[216:219], v[120:123], v[200:203], v[216:219]
    v_mfma_f32_16x16x32_bf16 v[220:223], v[124:127], v[200:203], v[220:223]
    v_mfma_f32_16x16x32_bf16 v[224:227], v[128:131], v[200:203], v[224:227]
    v_mfma_f32_16x16x32_bf16 v[228:231], v[132:135], v[200:203], v[228:231]
    s_waitcnt vmcnt(2) lgkmcnt(15)
    v_mfma_f32_16x16x32_bf16 v[216:219], v[136:139], v[204:207], v[216:219]
    v_mfma_f32_16x16x32_bf16 v[220:223], v[140:143], v[204:207], v[220:223]
    v_mfma_f32_16x16x32_bf16 v[224:227], v[144:147], v[204:207], v[224:227]
    v_mfma_f32_16x16x32_bf16 v[228:231], v[148:151], v[204:207], v[228:231]
    s_waitcnt vmcnt(1) lgkmcnt(8)
    v_mfma_f32_16x16x32_bf16 v[216:219], v[72:75], v[208:211], v[216:219]
    v_mfma_f32_16x16x32_bf16 v[220:223], v[76:79], v[208:211], v[220:223]
    v_mfma_f32_16x16x32_bf16 v[224:227], v[80:83], v[208:211], v[224:227]
    v_mfma_f32_16x16x32_bf16 v[228:231], v[84:87], v[208:211], v[228:231]
    s_waitcnt vmcnt(0) lgkmcnt(0)
    v_mfma_f32_16x16x32_bf16 v[216:219], v[232:235], v[212:215], v[216:219]
    v_mfma_f32_16x16x32_bf16 v[220:223], v[236:239], v[212:215], v[220:223]
    v_mfma_f32_16x16x32_bf16 v[224:227], v[240:243], v[212:215], v[224:227]
    v_mfma_f32_16x16x32_bf16 v[228:231], v[244:247], v[212:215], v[228:231]
    s_nop 4
    v_cvt_pk_bf16_f32 v72, v216, v217
    v_cvt_pk_bf16_f32 v73, v218, v219
    v_cvt_pk_bf16_f32 v74, v220, v221
    v_cvt_pk_bf16_f32 v75, v222, v223
    s_nop 1
    v_mfma_f32_16x16x32_bf16 v[156:159], v[72:75], v[72:75], 0
    v_mfma_f32_16x16x32_bf16 v[152:155], v[48:51], v[72:75], 0
    v_cvt_pk_bf16_f32 v76, v224, v225
    v_cvt_pk_bf16_f32 v77, v226, v227
    v_cvt_pk_bf16_f32 v78, v228, v229
    v_cvt_pk_bf16_f32 v79, v230, v231
    s_nop 1
    v_mfma_f32_16x16x32_bf16 v[156:159], v[76:79], v[76:79], v[156:159]
    v_mfma_f32_16x16x32_bf16 v[152:155], v[52:55], v[76:79], v[152:155]
    s_nop 7
    v_cndmask_b32 v154, v156, v157, s[66:67]
    v_cndmask_b32 v154, v154, v158, s[68:69]
    v_cndmask_b32 v154, v154, v159, s[70:71]
    v_mov_b32 v155, s49
    s_mov_b64 exec, s[64:65]
    s_cmp_eq_u32 s51, 0
    s_cbranch_scc1 LS_27
    buffer_store_dwordx4 v[152:155], v248, s[20:23], s60 offen
LS_28:
    s_mov_b64 exec, -1
    s_cmp_lg_u32 s53, 0
    s_cbranch_scc1 LG_29
    ds_write2_b64 v31, v[72:73], v[74:75] offset0:0 offset1:4
    ds_write2_b64 v31, v[76:77], v[78:79] offset0:8 offset1:12
    ds_read_b128 v[216:219], v28
    ds_read_b128 v[220:223], v28 offset:1152
    s_add_u32 s56, s91, 16384
    s_waitcnt lgkmcnt(0)
    s_cmp_eq_u32 s51, 0
    s_cbranch_scc1 LS_30
    buffer_store_dwordx4 v[216:219], v4, s[24:27], s91 offen
    buffer_store_dwordx4 v[220:223], v4, s[24:27], s56 offen
LS_31:
LG_29:
    s_cmp_lt_i32 s54, 0
    s_cbranch_scc1 LG_32
    v_lshlrev_b32 v244, 7, v1
    v_lshl_add_u32 v244, v2, 4, v244
    s_lshl_b32 s57, s44, 9
    s_add_u32 s57, s57, 157696
    v_add_u32 v244, s57, v244
    v_lshlrev_b32 v241, 2, v0
    v_add_u32 v241, 157696, v241
    v_lshrrev_b32 v242, 5, v0
    v_lshlrev_b32 v242, 6, v242
    v_bfe_u32 v243, v0, 2, 2
    v_lshl_add_u32 v242, v243, 4, v242
    v_bfe_u32 v243, v0, 4, 1
    v_lshl_add_u32 v242, v243, 3, v242
    v_and_b32 v243, 3, v0
    v_lshl_add_u32 v242, v243, 1, v242
    v_add_u32 v242, 161664, v242
    v_lshrrev_b32 v246, 3, v1
    v_lshlrev_b32 v243, 6, v246
    v_lshl_add_u32 v243, v2, 4, v243
    v_and_b32 v247, 3, v1
    v_lshlrev_b32 v245, 7, v247
    v_sub_u32 v243, v243, v245
    v_add_u32 v243, 161664, v243
    v_mul_u32_u24 v245, 57344, v246
    v_lshl_add_u32 v245, v247, 4, v245
    v_lshrrev_b32 v246, 1, v2
    v_mul_u32_u24 v246, 7168, v246
    v_add_u32 v245, v245, v246
    v_and_b32 v246, 1, v2
    v_lshl_add_u32 v245, v246, 6, v245
    v_lshlrev_b32 v247, 4, v2
LG_32:
    buffer_load_dwordx4 v[168:171], v3, s[20:23], s97 offen sc1
    buffer_load_dwordx4 v[172:175], v3, s[20:23], s97 offen offset:1024 sc1
    v_lshlrev_b32 v56, 16, v72
    v_and_b32 v57, 0xffff0000, v72
    v_lshlrev_b32 v58, 16, v73
    v_and_b32 v59, 0xffff0000, v73
    v_lshlrev_b32 v60, 16, v74
    v_and_b32 v61, 0xffff0000, v74
    v_lshlrev_b32 v62, 16, v75
    v_and_b32 v63, 0xffff0000, v75
    v_lshlrev_b32 v64, 16, v76
    v_and_b32 v65, 0xffff0000, v76
    v_lshlrev_b32 v66, 16, v77
    v_and_b32 v67, 0xffff0000, v77
    v_lshlrev_b32 v68, 16, v78
    v_and_b32 v69, 0xffff0000, v78
    v_lshlrev_b32 v70, 16, v79
    v_and_b32 v71, 0xffff0000, v79
    s_lshl_b32 s56, s55, 5
    v_lshl_or_b32 v208, v1, 1, s56
    s_mov_b32 s57, 0xfffff000
    s_mul_i32 s56, s44, 2304
    s_add_u32 s56, s56, 147456
    v_lshlrev_b32 v210, 4, v2
    v_add_u32 v210, s56, v210
    v_add_u32 v211, 128, v210
    v_add_u32 v213, s56, v3
    v_lshrrev_b32 v214, 3, v0
    v_mul_u32_u24 v214, 896, v214
    v_add_u32 v214, v214, v3
    v_lshlrev_b32 v212, 11, v0
    v_mov_b32 v186, s49
    v_mov_b32 v187, 0
    s_add_u32 s59, s96, 8192
    s_cmp_lg_u32 s53, 0
    s_waitcnt vmcnt(0)
    s_cbranch_scc1 LG_33
    s_mov_b64 exec, 1
    s_cmp_eq_u32 s51, 0
    s_cbranch_scc1 LS_34
    buffer_store_dword v186, off, s[20:23], s59
LS_35:
    s_mov_b64 exec, -1
LG_33:
    v_cmp_ne_u32 vcc, s49, v171
    v_cmp_ne_u32 s[6:7], s49, v175
    s_nop 0
    s_or_b64 vcc, vcc, s[6:7]
    s_cbranch_vccnz LP_37
LP_38:
    s_and_b32 s62, s59, 0xffffff80
    buffer_load_dword v215, v30, s[20:23], s62 offen sc1
    v_pk_add_f32 v[168:169], v[168:169], v[172:173]
    v_add_f32 v170, v170, v174
    v_mov_b32 v172, v168
    v_mov_b32 v173, v169
    v_mov_b32 v174, v170
    v_permlane32_swap_b32 v168, v172
    v_permlane32_swap_b32 v169, v173
    v_permlane32_swap_b32 v170, v174
    v_add_f32 v168, v168, v172
    v_add_f32 v169, v169, v173
    v_add_f32 v170, v170, v174
    v_mov_b32 v172, v168
    v_mov_b32 v173, v169
    v_mov_b32 v174, v170
    v_permlane16_swap_b32 v168, v172
    v_permlane16_swap_b32 v169, v173
    v_permlane16_swap_b32 v170, v174
    v_add_f32 v168, v168, v172
    v_add_f32 v169, v169, v173
    v_add_f32 v170, v170, v174
    v_mul_f32 v176, s88, v168
    v_mul_f32 v170, s88, v170
    v_fma_f32 v170, -v176, v176, v170
    v_max_f32 v170, 0, v170
    v_add_f32 v180, s89, v170
    v_rsq_f32 v180, v180
    v_fma_f32 v169, -v176, v25, v169
    v_mul_f32 v169, v169, v180
    v_mul_f32 v181, -v176, v180
    v_ashrrev_i32 v209, 31, v169
    v_or_b32 v209, 0x80000000, v209
    v_xor_b32 v209, v209, v169
    v_and_or_b32 v29, v209, s57, v208
    v_pk_fma_f32 v[192:193], v[56:57], v[180:181], v[180:181] op_sel:[0,0,1] op_sel_hi:[1,0,1]
    v_pk_fma_f32 v[194:195], v[58:59], v[180:181], v[180:181] op_sel:[0,0,1] op_sel_hi:[1,0,1]
    v_max_u32_dpp v184, v29, v29 row_ror:8 row_mask:0xf bank_mask:0xf
    v_pk_fma_f32 v[196:197], v[60:61], v[180:181], v[180:181] op_sel:[0,0,1] op_sel_hi:[1,0,1]
    v_pk_fma_f32 v[198:199], v[62:63], v[180:181], v[180:181] op_sel:[0,0,1] op_sel_hi:[1,0,1]
    v_max_u32_dpp v184, v184, v184 row_ror:4 row_mask:0xf bank_mask:0xf
    v_pk_fma_f32 v[200:201], v[64:65], v[180:181], v[180:181] op_sel:[0,0,1] op_sel_hi:[1,0,1]
    v_pk_fma_f32 v[202:203], v[66:67], v[180:181], v[180:181] op_sel:[0,0,1] op_sel_hi:[1,0,1]
    v_max_u32_dpp v184, v184, v184 row_ror:2 row_mask:0xf bank_mask:0xf
    v_pk_fma_f32 v[204:205], v[68:69], v[180:181], v[180:181] op_sel:[0,0,1] op_sel_hi:[1,0,1]
    v_pk_fma_f32 v[206:207], v[70:71], v[180:181], v[180:181] op_sel:[0,0,1] op_sel_hi:[1,0,1]
    v_max_u32_dpp v184, v184, v184 row_ror:1 row_mask:0xf bank_mask:0xf
    v_cmp_eq_u32 vcc, v184, v29
    s_add_u32 s56, s44, 4
    s_cmp_lg_u32 s56, s45
    v_cndmask_b32 v185, v29, v187, vcc
    v_cvt_pk_bf16_f32 v80, v192, v193
    v_cvt_pk_bf16_f32 v81, v194, v195
    v_max_u32_dpp v185, v185, v185 row_ror:8 row_mask:0xf bank_mask:0xf
    v_cvt_pk_bf16_f32 v82, v196, v197
    v_cvt_pk_bf16_f32 v83, v198, v199
    v_max_u32_dpp v185, v185, v185 row_ror:4 row_mask:0xf bank_mask:0xf
    v_cvt_pk_bf16_f32 v84, v200, v201
    v_cvt_pk_bf16_f32 v85, v202, v203
    v_max_u32_dpp v185, v185, v185 row_ror:2 row_mask:0xf bank_mask:0xf
    v_cvt_pk_bf16_f32 v86, v204, v205
    v_cvt_pk_bf16_f32 v87, v206, v207
    v_max_u32_dpp v185, v185, v185 row_ror:1 row_mask:0xf bank_mask:0xf
    v_cmp_eq_u32 s[6:7], v185, v29
    v_or_b32 v185, 1, v185
    s_cbranch_scc1 LR_42
    s_mov_b64 exec, 0xff
    buffer_store_dwordx4 v[184:187], v212, s[20:23], s98 offen sc1
    s_mov_b64 exec, -1
LR_42:
    v_cndmask_b32 v210, v210, v211, s[6:7]
    s_or_b64 exec, vcc, s[6:7]
    ds_write_b128 v210, v[80:83]
    ds_write_b128 v210, v[84:87] offset:64
    s_mov_b64 exec, -1
    ds_read_b128 v[172:175], v213
    s_cmp_lg_u32 s56, s45
    s_cbranch_scc1 LR_43
    s_waitcnt vmcnt(1)
    s_branch LR_44
LR_43:
    s_waitcnt vmcnt(0)
LR_44:
    v_cmp_ne_u32 vcc, s49, v215
    s_sub_u32 s86, 2, s85
    s_cmp_lg_u32 s53, 0
    s_cselect_b32 s86, 0, s86
    s_cmp_eq_u64 vcc, 0
    s_cselect_b32 s86, s86, 0
    s_cmp_lg_u32 s86, 1
    s_cbranch_scc1 LX_45
    s_lshl_b32 s73, s50, 7
    s_add_u32 m0, s74, 0
    s_add_u32 s78, s72, s73
    buffer_load_dwordx4 v4, s[24:27], s78 offen sc1 lds
    s_add_u32 m0, s74, 1024
    s_add_u32 s78, s78, 16384
    buffer_load_dwordx4 v4, s[24:27], s78 offen sc1 lds
    s_add_u32 s73, s73, 128
    s_and_b32 s73, s73, 1023
    s_add_u32 m0, s74, 10240
    s_add_u32 s78, s72, s73
    buffer_load_dwordx4 v4, s[24:27], s78 offen sc1 lds
    s_add_u32 m0, s74, 11264
    s_add_u32 s78, s78, 16384
    buffer_load_dwordx4 v4, s[24:27], s78 offen sc1 lds
    s_add_u32 s73, s73, 128
    s_and_b32 s73, s73, 1023
LX_45:
    s_mov_b64 exec, 0xffff
    s_waitcnt lgkmcnt(0)
    buffer_store_dwordx4 v[172:175], v214, s[20:23], s100 offen sc1
    s_mov_b64 exec, -1
    s_cmp_lg_u32 s53, 0
    s_cbranch_scc1 LU_46
    s_cmp_lg_u32 s44, 3
    s_cbranch_scc1 LU_48
    s_lshl_b32 s60, s45, 7
    s_lshl_b32 s61, s48, 14
    s_add_u32 s61, s61, s60
    s_add_u32 s61, s61, 1441792
    buffer_store_dwordx4 v[220:223], v4, s[20:23], s61 offen sc1
    v_add_f32 v179, 1.0, v180
    v_mul_f32 v177, v179, v179
    v_fma_f32 v177, v177, v170, s89
    v_rsq_f32 v177, v177
    s_nop 0
    v_mul_f32 v177, v177, v179
    s_lshl_b32 s61, s48, 10
    s_add_u32 s60, s60, s61
    s_add_u32 s60, s60, 1409024
    v_lshlrev_b32 v179, 3, v1
    s_mov_b64 exec, 0xffff
    buffer_store_dwordx2 v[176:177], v179, s[20:23], s60 offen sc1
    s_mov_b64 exec, -1
LU_48:
    s_cmp_lg_u32 s85, 0
    s_cbranch_scc1 LU_49
    v_lshrrev_b32 v232, 2, v0
    v_lshlrev_b32 v232, 6, v232
    v_and_b32 v233, 3, v0
    v_lshlrev_b32 v233, 3, v233
    v_and_b32 v234, 1, v2
    v_lshlrev_b32 v234, 5, v234
    v_xor_b32 v235, v233, v234
    v_add3_u32 v235, v235, v232, s73
    v_xor_b32 v236, 32, v235
    ds_read_b64_tr_b16 a[192:193], v235 offset:1024
    ds_read_b64_tr_b16 a[194:195], v235 offset:2048
    ds_read_b64_tr_b16 a[196:197], v236 offset:1024
    ds_read_b64_tr_b16 a[198:199], v236 offset:2048
    ds_read_b64_tr_b16 a[200:201], v235 offset:3072
    ds_read_b64_tr_b16 a[202:203], v235 offset:4096
    ds_read_b64_tr_b16 a[204:205], v236 offset:3072
    ds_read_b64_tr_b16 a[206:207], v236 offset:4096
    ds_read_b64_tr_b16 a[208:209], v235 offset:5120
    ds_read_b64_tr_b16 a[210:211], v235 offset:6144
    ds_read_b64_tr_b16 a[212:213], v236 offset:5120
    ds_read_b64_tr_b16 a[214:215], v236 offset:6144
    ds_read_b64_tr_b16 a[216:217], v235 offset:7168
    ds_read_b64_tr_b16 a[218:219], v235 offset:8192
    ds_read_b64_tr_b16 a[220:221], v236 offset:7168
    ds_read_b64_tr_b16 a[222:223], v236 offset:8192
    v_lshlrev_b32 v237, 4, v232
    v_lshlrev_b32 v238, 1, v233
    v_xor_b32 v238, v238, v234
    v_add_u32 v237, v237, v238
    s_lshl_b32 s58, s54, 15
    s_lshl_b32 s57, s44, 8
    s_add_u32 s58, s58, s57
    v_and_b32 v238, 3, v0
    v_lshl_add_u32 v238, v238, 11, v232
    v_xor_b32 v238, v238, v234
    v_add_u32 v238, s73, v238
    v_xor_b32 v239, 32, v238
    ds_read_b64_tr_b16 a[224:225], v235 offset:11264
    ds_read_b64_tr_b16 a[226:227], v235 offset:12288
    ds_read_b64_tr_b16 a[228:229], v236 offset:11264
    ds_read_b64_tr_b16 a[230:231], v236 offset:12288
    ds_read_b64_tr_b16 a[232:233], v235 offset:13312
    ds_read_b64_tr_b16 a[234:235], v235 offset:14336
    ds_read_b64_tr_b16 a[236:237], v236 offset:13312
    ds_read_b64_tr_b16 a[238:239], v236 offset:14336
    ds_read_b64_tr_b16 a[240:241], v235 offset:15360
    ds_read_b64_tr_b16 a[242:243], v235 offset:16384
    ds_read_b64_tr_b16 a[244:245], v236 offset:15360
    ds_read_b64_tr_b16 a[246:247], v236 offset:16384
    ds_read_b64_tr_b16 a[248:249], v235 offset:17408
    ds_read_b64_tr_b16 a[250:251], v235 offset:18432
    ds_read_b64_tr_b16 a[252:253], v236 offset:17408
    ds_read_b64_tr_b16 a[254:255], v236 offset:18432
    s_waitcnt lgkmcnt(15)
    s_add_u32 m0, s73, 1024
    s_add_u32 s78, s58, 0
    buffer_load_dwordx4 v237, s[36:39], s78 offen lds
    v_lshlrev_b32 v192, 16, v80
    v_and_b32 v193, 0xffff0000, v80
    v_lshlrev_b32 v194, 16, v81
    v_and_b32 v195, 0xffff0000, v81
    v_lshlrev_b32 v196, 16, v82
    v_and_b32 v197, 0xffff0000, v82
    v_lshlrev_b32 v198, 16, v83
    s_add_u32 m0, s73, 2048
    s_add_u32 s78, s58, 16384
    buffer_load_dwordx4 v237, s[36:39], s78 offen lds
    v_and_b32 v199, 0xffff0000, v83
    v_lshlrev_b32 v200, 16, v84
    v_and_b32 v201, 0xffff0000, v84
    v_lshlrev_b32 v202, 16, v85
    v_and_b32 v203, 0xffff0000, v85
    v_lshlrev_b32 v204, 16, v86
    v_and_b32 v205, 0xffff0000, v86
    s_add_u32 m0, s73, 3072
    s_add_u32 s78, s58, 64
    buffer_load_dwordx4 v237, s[36:39], s78 offen lds
    v_lshlrev_b32 v206, 16, v87
    v_and_b32 v207, 0xffff0000, v87
    v_pk_add_f32 v[192:193], v[192:193], v[56:57]
    v_pk_add_f32 v[194:195], v[194:195], v[58:59]
    v_pk_add_f32 v[196:197], v[196:197], v[60:61]
    v_pk_add_f32 v[198:199], v[198:199], v[62:63]
    v_pk_add_f32 v[200:201], v[200:201], v[64:65]
    s_add_u32 m0, s73, 4096
    s_add_u32 s78, s58, 16448
    buffer_load_dwordx4 v237, s[36:39], s78 offen lds
    v_pk_add_f32 v[202:203], v[202:203], v[66:67]
    v_pk_add_f32 v[204:205], v[204:205], v[68:69]
    v_pk_add_f32 v[206:207], v[206:207], v[70:71]
    v_cvt_pk_bf16_f32 v160, v192, v193
    v_cvt_pk_bf16_f32 v161, v194, v195
    v_cvt_pk_bf16_f32 v162, v196, v197
    v_cvt_pk_bf16_f32 v163, v198, v199
    s_add_u32 m0, s73, 5120
    s_add_u32 s78, s58, 128
    buffer_load_dwordx4 v237, s[36:39], s78 offen lds
    v_cvt_pk_bf16_f32 v164, v200, v201
    v_cvt_pk_bf16_f32 v165, v202, v203
    v_cvt_pk_bf16_f32 v166, v204, v205
    v_cvt_pk_bf16_f32 v167, v206, v207
    v_lshlrev_b32 v56, 16, v160
    v_and_b32 v57, 0xffff0000, v160
    v_lshlrev_b32 v58, 16, v161
    s_add_u32 m0, s73, 6144
    s_add_u32 s78, s58, 16512
    buffer_load_dwordx4 v237, s[36:39], s78 offen lds
    v_and_b32 v59, 0xffff0000, v161
    v_lshlrev_b32 v60, 16, v162
    v_and_b32 v61, 0xffff0000, v162
    v_lshlrev_b32 v62, 16, v163
    v_and_b32 v63, 0xffff0000, v163
    v_lshlrev_b32 v64, 16, v164
    v_and_b32 v65, 0xffff0000, v164
    s_add_u32 m0, s73, 7168
    s_add_u32 s78, s58, 192
    buffer_load_dwordx4 v237, s[36:39], s78 offen lds
    v_lshlrev_b32 v66, 16, v165
    v_and_b32 v67, 0xffff0000, v165
    v_lshlrev_b32 v68, 16, v166
    v_and_b32 v69, 0xffff0000, v166
    v_lshlrev_b32 v70, 16, v167
    v_and_b32 v71, 0xffff0000, v167
    v_add_f32 v179, 1.0, v180
    s_add_u32 m0, s73, 8192
    s_add_u32 s78, s58, 16576
    buffer_load_dwordx4 v237, s[36:39], s78 offen lds
    v_mul_f32 v178, v179, v179
    v_fma_f32 v178, v178, v170, s89
    v_rsq_f32 v178, v178
    s_nop 0
    v_mul_f32 v178, v178, v179
    s_lshr_b32 s56, s74, 5
    v_add_u32 v208, s56, v13
    ds_write2_b32 v208, v176, v178 offset0:0 offset1:80
    s_branch LU_47
LU_49:
    v_lshlrev_b32 v192, 16, v80
    v_and_b32 v193, 0xffff0000, v80
    v_lshlrev_b32 v194, 16, v81
    v_and_b32 v195, 0xffff0000, v81
    v_lshlrev_b32 v196, 16, v82
    v_and_b32 v197, 0xffff0000, v82
    v_lshlrev_b32 v198, 16, v83
    v_and_b32 v199, 0xffff0000, v83
    v_lshlrev_b32 v200, 16, v84
    v_and_b32 v201, 0xffff0000, v84
    v_lshlrev_b32 v202, 16, v85
    v_and_b32 v203, 0xffff0000, v85
    v_lshlrev_b32 v204, 16, v86
    v_and_b32 v205, 0xffff0000, v86
    v_lshlrev_b32 v206, 16, v87
    v_and_b32 v207, 0xffff0000, v87
    v_pk_add_f32 v[192:193], v[192:193], v[56:57]
    v_pk_add_f32 v[194:195], v[194:195], v[58:59]
    v_pk_add_f32 v[196:197], v[196:197], v[60:61]
    v_pk_add_f32 v[198:199], v[198:199], v[62:63]
    v_pk_add_f32 v[200:201], v[200:201], v[64:65]
    v_pk_add_f32 v[202:203], v[202:203], v[66:67]
    v_pk_add_f32 v[204:205], v[204:205], v[68:69]
    v_pk_add_f32 v[206:207], v[206:207], v[70:71]
    v_cvt_pk_bf16_f32 v160, v192, v193
    v_cvt_pk_bf16_f32 v161, v194, v195
    v_cvt_pk_bf16_f32 v162, v196, v197
    v_cvt_pk_bf16_f32 v163, v198, v199
    v_cvt_pk_bf16_f32 v164, v200, v201
    v_cvt_pk_bf16_f32 v165, v202, v203
    v_cvt_pk_bf16_f32 v166, v204, v205
    v_cvt_pk_bf16_f32 v167, v206, v207
    v_lshlrev_b32 v56, 16, v160
    v_and_b32 v57, 0xffff0000, v160
    v_lshlrev_b32 v58, 16, v161
    v_and_b32 v59, 0xffff0000, v161
    v_lshlrev_b32 v60, 16, v162
    v_and_b32 v61, 0xffff0000, v162
    v_lshlrev_b32 v62, 16, v163
    v_and_b32 v63, 0xffff0000, v163
    v_lshlrev_b32 v64, 16, v164
    v_and_b32 v65, 0xffff0000, v164
    v_lshlrev_b32 v66, 16, v165
    v_and_b32 v67, 0xffff0000, v165
    v_lshlrev_b32 v68, 16, v166
    v_and_b32 v69, 0xffff0000, v166
    v_lshlrev_b32 v70, 16, v167
    v_and_b32 v71, 0xffff0000, v167
    v_add_f32 v179, 1.0, v180
    v_mul_f32 v178, v179, v179
    v_fma_f32 v178, v178, v170, s89
    v_rsq_f32 v178, v178
    s_nop 0
    v_mul_f32 v178, v178, v179
    s_lshr_b32 s56, s74, 5
    v_add_u32 v208, s56, v13
    ds_write2_b32 v208, v176, v178 offset0:0 offset1:80
    s_branch LU_47
LU_46:
    v_lshlrev_b32 v192, 16, v80
    v_and_b32 v193, 0xffff0000, v80
    v_lshlrev_b32 v194, 16, v81
    v_and_b32 v195, 0xffff0000, v81
    v_lshlrev_b32 v196, 16, v82
    v_and_b32 v197, 0xffff0000, v82
    v_lshlrev_b32 v198, 16, v83
    v_and_b32 v199, 0xffff0000, v83
    v_lshlrev_b32 v200, 16, v84
    v_and_b32 v201, 0xffff0000, v84
    v_lshlrev_b32 v202, 16, v85
    v_and_b32 v203, 0xffff0000, v85
    v_lshlrev_b32 v204, 16, v86
    v_and_b32 v205, 0xffff0000, v86
    v_lshlrev_b32 v206, 16, v87
    v_and_b32 v207, 0xffff0000, v87
    v_pk_add_f32 v[192:193], v[192:193], v[56:57]
    v_pk_add_f32 v[194:195], v[194:195], v[58:59]
    v_pk_add_f32 v[196:197], v[196:197], v[60:61]
    v_pk_add_f32 v[198:199], v[198:199], v[62:63]
    v_pk_add_f32 v[200:201], v[200:201], v[64:65]
    v_pk_add_f32 v[202:203], v[202:203], v[66:67]
    v_pk_add_f32 v[204:205], v[204:205], v[68:69]
    v_pk_add_f32 v[206:207], v[206:207], v[70:71]
    v_cvt_pk_bf16_f32 v160, v192, v193
    v_cvt_pk_bf16_f32 v161, v194, v195
    v_cvt_pk_bf16_f32 v162, v196, v197
    v_cvt_pk_bf16_f32 v163, v198, v199
    v_cvt_pk_bf16_f32 v164, v200, v201
    v_cvt_pk_bf16_f32 v165, v202, v203
    v_cvt_pk_bf16_f32 v166, v204, v205
    v_cvt_pk_bf16_f32 v167, v206, v207
    ds_write2_b64 v31, v[160:161], v[162:163] offset0:0 offset1:4
    ds_write2_b64 v31, v[164:165], v[166:167] offset0:8 offset1:12
    ds_read_b128 v[216:219], v28
    ds_read_b128 v[220:223], v28 offset:1152
    s_add_u32 s56, s91, 16384
    s_waitcnt lgkmcnt(0)
    buffer_store_dwordx4 v[216:219], v4, s[24:27], s91 offen
    buffer_store_dwordx4 v[220:223], v4, s[24:27], s56 offen
LU_47:
    s_cmp_lt_i32 s54, 0
    s_cbranch_scc1 LM_51
    v_and_b32 v240, 1, v0
    s_lshl_b32 s62, s53, 18
    v_cmp_eq_u32 s[60:61], 1, v240
    s_lshl_b32 s57, s44, 8
    s_add_u32 s62, s62, s57
    s_add_u32 s62, s62, 655360
    s_mov_b32 s58, 0xbfb8aa3b
    s_mov_b32 s86, 0
    buffer_load_dwordx4 v[216:219], v3, s[20:23], s99 offen sc1
    buffer_load_dwordx4 v[220:223], v3, s[20:23], s99 offen offset:1024 sc1
    s_cmp_lg_u32 s85, 0
    s_cbranch_scc1 LG_54
    s_waitcnt vmcnt(2)
    ds_read_b64_tr_b16 v[88:89], v238 offset:1024
    ds_read_b64_tr_b16 v[90:91], v238 offset:2048
    ds_read_b64_tr_b16 v[92:93], v238 offset:1032
    ds_read_b64_tr_b16 v[94:95], v238 offset:2056
    ds_read_b64_tr_b16 v[96:97], v238 offset:1040
    ds_read_b64_tr_b16 v[98:99], v238 offset:2064
    ds_read_b64_tr_b16 v[100:101], v238 offset:1048
    ds_read_b64_tr_b16 v[102:103], v238 offset:2072
    ds_read_b64_tr_b16 v[104:105], v239 offset:1024
    ds_read_b64_tr_b16 v[106:107], v239 offset:2048
    ds_read_b64_tr_b16 v[108:109], v239 offset:1032
    ds_read_b64_tr_b16 v[110:111], v239 offset:2056
    ds_read_b64_tr_b16 v[112:113], v239 offset:1040
    ds_read_b64_tr_b16 v[114:115], v239 offset:2064
    ds_read_b64_tr_b16 v[116:117], v239 offset:1048
    ds_read_b64_tr_b16 v[118:119], v239 offset:2072
    v_mov_b32 v228, s49
    s_cmp_lg_u32 s44, 3
    s_cbranch_scc1 LV_55
    s_add_u32 s59, s96, 12288
    s_mov_b64 exec, 1
    buffer_store_dword v228, off, s[20:23], s59 sc1
    s_mov_b64 exec, -1
LV_55:
    s_add_u32 s59, s96, 8192
    s_and_b32 s59, s59, 0xffffff80
    buffer_load_dword v229, v30, s[20:23], s59 offen sc1
    s_waitcnt lgkmcnt(0)
    s_barrier
LG_54:
    s_waitcnt vmcnt(0)
    v_cmp_ne_u32 vcc, s49, v218
    v_cmp_ne_u32 s[6:7], s49, v222
    s_nop 0
    s_or_b64 vcc, vcc, s[6:7]
    s_cbranch_vccnz LP_57
LP_58:
    v_max_u32 v224, v216, v220
    v_min_u32 v228, v216, v220
    v_mov_b32 v226, v224
    v_max3_u32 v225, v228, v217, v221
    v_mov_b32 v227, v225
    v_permlane32_swap_b32 v224, v226
    s_nop 0
    v_permlane32_swap_b32 v225, v227
    v_min_u32 v228, v224, v226
    v_max_u32 v224, v224, v226
    v_max3_u32 v225, v225, v227, v228
    v_mov_b32 v226, v224
    v_mov_b32 v227, v225
    s_nop 0
    v_permlane16_swap_b32 v224, v226
    v_permlane16_swap_b32 v225, v227
    v_min_u32 v228, v224, v226
    v_max_u32 v224, v224, v226
    v_max3_u32 v225, v225, v227, v228
    s_nop 0
    v_min_u32_dpp v228, v224, v224 row_ror:8 row_mask:0xf bank_mask:0xf
    v_max_u32_dpp v227, v225, v225 row_ror:8 row_mask:0xf bank_mask:0xf
    v_max_u32_dpp v224, v224, v224 row_ror:8 row_mask:0xf bank_mask:0xf
    v_max_u32 v225, v227, v228
    s_nop 0
    v_min_u32_dpp v228, v224, v224 row_ror:4 row_mask:0xf bank_mask:0xf
    v_max_u32_dpp v227, v225, v225 row_ror:4 row_mask:0xf bank_mask:0xf
    v_max_u32_dpp v224, v224, v224 row_ror:4 row_mask:0xf bank_mask:0xf
    v_max_u32 v225, v227, v228
    s_nop 0
    v_min_u32_dpp v228, v224, v224 row_ror:2 row_mask:0xf bank_mask:0xf
    v_max_u32_dpp v227, v225, v225 row_ror:2 row_mask:0xf bank_mask:0xf
    v_max_u32_dpp v224, v224, v224 row_ror:2 row_mask:0xf bank_mask:0xf
    v_max_u32 v225, v227, v228
    s_nop 0
    v_min_u32_dpp v228, v224, v224 row_ror:1 row_mask:0xf bank_mask:0xf
    v_max_u32_dpp v227, v225, v225 row_ror:1 row_mask:0xf bank_mask:0xf
    v_max_u32_dpp v224, v224, v224 row_ror:1 row_mask:0xf bank_mask:0xf
    v_max_u32 v225, v227, v228
    s_mov_b32 s83, 0
    v_cndmask_b32 v240, v224, v225, s[60:61]
    v_bfe_u32 v246, v240, 5, 7
    v_and_b32 v240, 1, v240
    v_lshl_or_b32 v240, v246, 1, v240
    v_lshl_add_u32 v240, v240, 10, v247
    s_mov_b64 exec, s[4:5]
    buffer_load_dwordx4 v[152:155], v240, s[20:23], s62 offen offset:0 sc1
    buffer_load_dwordx4 v[156:159], v240, s[20:23], s62 offen offset:64 sc1
    buffer_load_dwordx4 v[160:163], v240, s[20:23], s62 offen offset:128 sc1
    buffer_load_dwordx4 v[164:167], v240, s[20:23], s62 offen offset:192 sc1
    s_mov_b64 exec, -1
    v_readfirstlane_b32 s81, v224
    v_readfirstlane_b32 s82, v225
LG_62:
    s_or_b32 s56, s53, s86
    s_cbranch_scc1 LG_63
    v_cmp_ne_u32 vcc, s49, v229
    s_nop 0
    s_cmp_eq_u64 vcc, 0
    s_cselect_b32 s86, 2, 0
    s_cbranch_scc0 LG_63
    s_lshl_b32 s73, s50, 7
    s_add_u32 m0, s74, 0
    s_add_u32 s78, s72, s73
    buffer_load_dwordx4 v4, s[24:27], s78 offen sc1 lds
    s_add_u32 m0, s74, 1024
    s_add_u32 s78, s78, 16384
    buffer_load_dwordx4 v4, s[24:27], s78 offen sc1 lds
    s_add_u32 s73, s73, 128
    s_and_b32 s73, s73, 1023
    s_add_u32 m0, s74, 10240
    s_add_u32 s78, s72, s73
    buffer_load_dwordx4 v4, s[24:27], s78 offen sc1 lds
    s_add_u32 m0, s74, 11264
    s_add_u32 s78, s78, 16384
    buffer_load_dwordx4 v4, s[24:27], s78 offen sc1 lds
    s_add_u32 s73, s73, 128
    s_and_b32 s73, s73, 1023
    s_call_b64 s[0:1], L_AFF
    s_cmp_lg_u32 s83, 0
    s_cbranch_scc1 LG_64
    s_waitcnt vmcnt(4)
    s_branch LG_64
LG_63:
    s_call_b64 s[0:1], L_AFF
    s_cmp_lg_u32 s83, 0
    s_cbranch_scc1 LG_64
    s_waitcnt vmcnt(0)
LG_64:
    s_mov_b64 exec, s[4:5]
    v_max3_u32 v246, v152, v153, v154
    v_max3_u32 v246, v246, v155, v156
    v_max3_u32 v246, v246, v157, v158
    v_max3_u32 v246, v246, v159, v160
    v_max3_u32 v246, v246, v161, v162
    v_max3_u32 v246, v246, v163, v164
    v_max3_u32 v246, v246, v165, v166
    v_max_u32 v246, v246, v167
    v_cmp_eq_u32 vcc, -1, v246
    s_cbranch_vccnz LR_67
LR_65:
    s_mov_b64 exec, -1
    v_mfma_f32_16x16x32_bf16 v[168:171], a[192:195], v[152:155], 0
    v_mfma_f32_16x16x32_bf16 v[172:175], a[196:199], v[152:155], 0
    v_mfma_f32_16x16x32_bf16 v[176:179], a[224:227], v[152:155], 0
    v_mfma_f32_16x16x32_bf16 v[180:183], a[228:231], v[152:155], 0
    v_mfma_f32_16x16x32_bf16 v[168:171], a[200:203], v[156:159], v[168:171]
    v_mfma_f32_16x16x32_bf16 v[172:175], a[204:207], v[156:159], v[172:175]
    v_mfma_f32_16x16x32_bf16 v[176:179], a[232:235], v[156:159], v[176:179]
    v_mfma_f32_16x16x32_bf16 v[180:183], a[236:239], v[156:159], v[180:183]
    v_mfma_f32_16x16x32_bf16 v[168:171], a[208:211], v[160:163], v[168:171]
    v_mfma_f32_16x16x32_bf16 v[172:175], a[212:215], v[160:163], v[172:175]
    v_mfma_f32_16x16x32_bf16 v[176:179], a[240:243], v[160:163], v[176:179]
    v_mfma_f32_16x16x32_bf16 v[180:183], a[244:247], v[160:163], v[180:183]
    v_mfma_f32_16x16x32_bf16 v[168:171], a[216:219], v[164:167], v[168:171]
    v_mfma_f32_16x16x32_bf16 v[172:175], a[220:223], v[164:167], v[172:175]
    v_mfma_f32_16x16x32_bf16 v[176:179], a[248:251], v[164:167], v[176:179]
    v_mfma_f32_16x16x32_bf16 v[180:183], a[252:255], v[164:167], v[180:183]
    s_lshl_b32 s56, s45, 2
    s_add_u32 s56, s56, s44
    s_cmp_lg_u32 s56, 4
    s_cbranch_scc1 LZ_68
    v_mov_b32 v226, s49
    s_lshl_b32 s56, s53, 3
    s_add_u32 s56, s56, s46
    s_lshl_b32 s56, s56, 7
    s_add_u32 s56, s56, 28672
    s_mov_b64 exec, 1
    buffer_store_dwordx4 v[224:227], off, s[20:23], s56 sc1
LZ_68:
    s_mov_b64 exec, s[4:5]
    ds_write_b128 v244, v[168:171] offset:0
    ds_write_b128 v244, v[172:175] offset:64
    ds_write_b128 v244, v[176:179] offset:256
    ds_write_b128 v244, v[180:183] offset:320
    s_mov_b64 exec, -1
    s_waitcnt lgkmcnt(0)
    s_barrier
    ds_read2st64_b32 v[168:169], v241 offset0:0 offset1:1
    ds_read2st64_b32 v[170:171], v241 offset0:2 offset1:3
    ds_read2st64_b32 v[172:173], v241 offset0:4 offset1:5
    ds_read2st64_b32 v[174:175], v241 offset0:6 offset1:7
    s_waitcnt lgkmcnt(2)
    v_pk_add_f32 v[168:169], v[168:169], v[170:171]
    s_waitcnt lgkmcnt(0)
    v_pk_add_f32 v[172:173], v[172:173], v[174:175]
    v_pk_add_f32 v[168:169], v[168:169], v[172:173]
    v_cvt_pk_bf16_f32 v170, v168, v169
    v_lshlrev_b32 v168, 16, v170
    v_mul_f32 v171, s58, v168
    v_exp_f32 v171, v171
    v_and_b32 v169, 0xffff0000, v170
    v_add_f32 v171, 1.0, v171
    v_rcp_f32 v171, v171
    s_nop 0
    v_mul_f32 v168, v168, v171
    v_cvt_pk_bf16_f32 v168, v168, v168
    v_and_b32 v168, 0xffff0000, v168
    v_mul_f32 v168, v168, v169
    v_cvt_pk_bf16_f32 v168, v168, v168
    ds_write_b16 v242, v168
    ds_read_b128 v[184:187], v243 offset:0
    ds_read_b128 v[188:191], v243 offset:128
    ds_read_b128 v[192:195], v243 offset:256
    ds_read_b128 v[196:199], v243 offset:384
    s_mov_b32 s56, 0x0f0f0f0f
    s_waitcnt lgkmcnt(3)
    v_mfma_f32_16x16x32_bf16 v[172:175], v[88:91], v[184:187], 0
    v_mfma_f32_16x16x32_bf16 v[176:179], v[92:95], v[184:187], 0
    s_waitcnt lgkmcnt(2)
    v_mfma_f32_16x16x32_bf16 v[172:175], v[96:99], v[188:191], v[172:175]
    v_mfma_f32_16x16x32_bf16 v[176:179], v[100:103], v[188:191], v[176:179]
    s_waitcnt lgkmcnt(1)
    v_mfma_f32_16x16x32_bf16 v[172:175], v[104:107], v[192:195], v[172:175]
    v_mfma_f32_16x16x32_bf16 v[176:179], v[108:111], v[192:195], v[176:179]
    s_waitcnt lgkmcnt(0)
    v_mfma_f32_16x16x32_bf16 v[172:175], v[112:115], v[196:199], v[172:175]
    v_mfma_f32_16x16x32_bf16 v[176:179], v[116:119], v[196:199], v[176:179]
    s_mov_b32 exec_lo, s56
    s_mov_b32 exec_hi, s56
    s_nop 4
    v_cvt_pk_bf16_f32 v168, v172, v173
    v_cvt_pk_bf16_f32 v169, v174, v175
    v_cvt_pk_bf16_f32 v170, v176, v177
    v_cvt_pk_bf16_f32 v171, v178, v179
    buffer_store_dwordx4 v[168:171], v245, s[20:23], s101 offen sc1
    s_mov_b64 exec, -1
LM_51:
    s_cmp_lg_u32 s53, 0
    s_cbranch_scc1 L_POST1
    s_lshl_b32 s56, s48, 7
    s_add_u32 s56, s56, 16384
    s_cmp_lg_u32 s86, 0
    s_cbranch_scc1 LE_69
    s_lshl_b32 s73, s50, 7
    buffer_load_dword v242, v30, s[20:23], s56 offen sc1
    s_waitcnt vmcnt(0)
    v_cmp_ne_u32 vcc, s49, v242
    s_cbranch_vccnz LP_71
LP_72:
    s_add_u32 m0, s74, 0
    s_add_u32 s78, s72, s73
    buffer_load_dwordx4 v4, s[24:27], s78 offen sc1 lds
    s_add_u32 m0, s74, 1024
    s_add_u32 s78, s78, 16384
    buffer_load_dwordx4 v4, s[24:27], s78 offen sc1 lds
    s_add_u32 s73, s73, 128
    s_and_b32 s73, s73, 1023
    s_add_u32 m0, s74, 10240
    s_add_u32 s78, s72, s73
    buffer_load_dwordx4 v4, s[24:27], s78 offen sc1 lds
    s_add_u32 m0, s74, 11264
    s_add_u32 s78, s78, 16384
    buffer_load_dwordx4 v4, s[24:27], s78 offen sc1 lds
    s_add_u32 s73, s73, 128
    s_and_b32 s73, s73, 1023
LE_69:
    s_add_u32 m0, s74, 20480
    s_add_u32 s78, s72, s73
    buffer_load_dwordx4 v4, s[24:27], s78 offen sc1 lds
    s_add_u32 m0, s74, 21504
    s_add_u32 s78, s78, 16384
    buffer_load_dwordx4 v4, s[24:27], s78 offen sc1 lds
    s_add_u32 s73, s73, 128
    s_and_b32 s73, s73, 1023
    s_lshl_b32 s59, s48, 10
    s_add_u32 s59, s59, 1408000
    s_lshl_b32 s58, s45, 7
    s_add_u32 s59, s59, s58
    s_lshl_b32 s76, s48, 14
    s_add_u32 s76, s76, 1425408
    v_lshlrev_b32 v230, 3, v1
    s_add_u32 s62, s56, 3980
    s_cmp_eq_u32 s44, 3
    s_cselect_b32 s61, 2, 1
    s_cmp_eq_u32 s86, 1
    s_cselect_b32 s61, s61, 0
    s_cmp_eq_u32 s86, 2
    s_cselect_b32 s61, 1, s61
    v_and_b32 v240, 7, v0
    v_lshlrev_b32 v240, 4, v240
    s_cmp_eq_u32 s61, 1
    s_cbranch_scc0 LW_75
    s_waitcnt vmcnt(5) lgkmcnt(0)
LW_77:
    s_barrier
    ds_read_b128 v[212:215], v5 offset:2048
    ds_read_b128 v[216:219], v5 offset:4096
    ds_read_b128 v[220:223], v5 offset:6144
    ds_read_b128 v[224:227], v5 offset:8192
    s_waitcnt lgkmcnt(0)
    v_mfma_f32_16x16x32_bf16 v[156:159], a[64:67], v[212:215], 0
    ds_read_b128 v[120:123], v6 offset:2048
    s_add_u32 m0, s74, 30720
    v_mfma_f32_16x16x32_bf16 v[176:179], v[212:215], a[128:131], 0
    ds_read_b128 v[124:127], v6 offset:4096
    s_add_u32 s78, s72, s73
    v_mfma_f32_16x16x32_bf16 v[196:199], a[0:3], v[212:215], 0
    buffer_load_dwordx4 v4, s[24:27], s78 offen sc1 lds
    v_mfma_f32_16x16x32_bf16 v[160:163], a[64:67], v[216:219], 0
    ds_read_b128 v[128:131], v6 offset:6144
    s_add_u32 m0, s74, 31744
    v_mfma_f32_16x16x32_bf16 v[180:183], v[216:219], a[128:131], 0
    ds_read_b128 v[132:135], v6 offset:8192
    s_add_u32 s78, s78, 16384
    v_mfma_f32_16x16x32_bf16 v[200:203], a[0:3], v[216:219], 0
    v_mfma_f32_16x16x32_bf16 v[164:167], a[64:67], v[220:223], 0
    buffer_load_dwordx4 v4, s[24:27], s78 offen sc1 lds
    s_add_u32 s73, s73, 128
    v_mfma_f32_16x16x32_bf16 v[184:187], v[220:223], a[128:131], 0
    s_and_b32 s73, s73, 1023
    v_mfma_f32_16x16x32_bf16 v[204:207], a[0:3], v[220:223], 0
    s_add_u32 m0, s74, 40960
    v_mfma_f32_16x16x32_bf16 v[168:171], a[64:67], v[224:227], 0
    s_add_u32 s78, s72, s73
    v_mfma_f32_16x16x32_bf16 v[188:191], v[224:227], a[128:131], 0
    buffer_load_dwordx4 v4, s[24:27], s78 offen sc1 lds
    v_mfma_f32_16x16x32_bf16 v[208:211], a[0:3], v[224:227], 0
    s_add_u32 m0, s74, 41984
    s_add_u32 s78, s78, 16384
    buffer_load_dwordx4 v4, s[24:27], s78 offen sc1 lds
    s_add_u32 s73, s73, 128
    s_and_b32 s73, s73, 1023
    s_cmp_eq_u32 s61, 1
    s_cbranch_scc0 LW_78
    s_waitcnt vmcnt(7) lgkmcnt(0)
LW_80:
    s_barrier
    v_mfma_f32_16x16x32_bf16 v[156:159], a[68:71], v[120:123], v[156:159]
    ds_read_b128 v[212:215], v5 offset:12288
    s_add_u32 m0, s74, 51200
    v_mfma_f32_16x16x32_bf16 v[176:179], v[120:123], a[132:135], v[176:179]
    ds_read_b128 v[216:219], v5 offset:14336
    s_add_u32 s78, s72, s73
    v_mfma_f32_16x16x32_bf16 v[196:199], a[4:7], v[120:123], v[196:199]
    buffer_load_dwordx4 v4, s[24:27], s78 offen sc1 lds
    v_mfma_f32_16x16x32_bf16 v[160:163], a[68:71], v[124:127], v[160:163]
    ds_read_b128 v[220:223], v5 offset:16384
    s_add_u32 m0, s74, 52224
    v_mfma_f32_16x16x32_bf16 v[180:183], v[124:127], a[132:135], v[180:183]
    ds_read_b128 v[224:227], v5 offset:18432
    s_add_u32 s78, s78, 16384
    v_mfma_f32_16x16x32_bf16 v[200:203], a[4:7], v[124:127], v[200:203]
    v_mfma_f32_16x16x32_bf16 v[164:167], a[68:71], v[128:131], v[164:167]
    buffer_load_dwordx4 v4, s[24:27], s78 offen sc1 lds
    s_add_u32 s73, s73, 128
    v_mfma_f32_16x16x32_bf16 v[184:187], v[128:131], a[132:135], v[184:187]
    s_and_b32 s73, s73, 1023
    v_mfma_f32_16x16x32_bf16 v[204:207], a[4:7], v[128:131], v[204:207]
    s_add_u32 m0, s74, 61440
    v_mfma_f32_16x16x32_bf16 v[168:171], a[68:71], v[132:135], v[168:171]
    s_add_u32 s78, s72, s73
    v_mfma_f32_16x16x32_bf16 v[188:191], v[132:135], a[132:135], v[188:191]
    buffer_load_dwordx4 v4, s[24:27], s78 offen sc1 lds
    v_mfma_f32_16x16x32_bf16 v[208:211], a[4:7], v[132:135], v[208:211]
    s_add_u32 m0, s74, 62464
    s_add_u32 s78, s78, 16384
    buffer_load_dwordx4 v4, s[24:27], s78 offen sc1 lds
    s_add_u32 s73, s73, 128
    s_and_b32 s73, s73, 1023
    s_waitcnt lgkmcnt(0)
    v_mfma_f32_16x16x32_bf16 v[156:159], a[72:75], v[212:215], v[156:159]
    ds_read_b128 v[120:123], v6 offset:12288
    s_add_u32 m0, s74, 71680
    v_mfma_f32_16x16x32_bf16 v[176:179], v[212:215], a[136:139], v[176:179]
    ds_read_b128 v[124:127], v6 offset:14336
    s_add_u32 s78, s72, s73
    v_mfma_f32_16x16x32_bf16 v[196:199], a[8:11], v[212:215], v[196:199]
    buffer_load_dwordx4 v4, s[24:27], s78 offen sc1 lds
    v_mfma_f32_16x16x32_bf16 v[160:163], a[72:75], v[216:219], v[160:163]
    ds_read_b128 v[128:131], v6 offset:16384
    s_add_u32 m0, s74, 72704
    v_mfma_f32_16x16x32_bf16 v[180:183], v[216:219], a[136:139], v[180:183]
    ds_read_b128 v[132:135], v6 offset:18432
    s_add_u32 s78, s78, 16384
    v_mfma_f32_16x16x32_bf16 v[200:203], a[8:11], v[216:219], v[200:203]
    v_mfma_f32_16x16x32_bf16 v[164:167], a[72:75], v[220:223], v[164:167]
    buffer_load_dwordx4 v4, s[24:27], s78 offen sc1 lds
    s_add_u32 s73, s73, 128
    v_mfma_f32_16x16x32_bf16 v[184:187], v[220:223], a[136:139], v[184:187]
    s_and_b32 s73, s73, 1023
    v_mfma_f32_16x16x32_bf16 v[204:207], a[8:11], v[220:223], v[204:207]
    v_mfma_f32_16x16x32_bf16 v[168:171], a[72:75], v[224:227], v[168:171]
    v_mfma_f32_16x16x32_bf16 v[188:191], v[224:227], a[136:139], v[188:191]
    v_mfma_f32_16x16x32_bf16 v[208:211], a[8:11], v[224:227], v[208:211]
    s_waitcnt vmcnt(10) lgkmcnt(0)
    s_barrier
    s_cmp_lg_u32 s44, 3
    s_cbranch_scc1 LV_81
    s_cmp_ge_i32 s54, 0
    s_cbranch_scc1 LV_81
    s_add_u32 s58, s96, 12288
    v_mov_b32 v242, s49
    s_mov_b64 exec, 1
    buffer_store_dword v242, off, s[20:23], s58 sc1
    s_mov_b64 exec, -1
LV_81:
    v_mfma_f32_16x16x32_bf16 v[156:159], a[76:79], v[120:123], v[156:159]
    ds_read_b128 v[212:215], v5 offset:22528
    v_mfma_f32_16x16x32_bf16 v[176:179], v[120:123], a[140:143], v[176:179]
    ds_read_b128 v[216:219], v5 offset:24576
    v_mfma_f32_16x16x32_bf16 v[196:199], a[12:15], v[120:123], v[196:199]
    ds_read_b128 v[220:223], v5 offset:26624
    v_mfma_f32_16x16x32_bf16 v[160:163], a[76:79], v[124:127], v[160:163]
    ds_read_b128 v[224:227], v5 offset:28672
    v_mfma_f32_16x16x32_bf16 v[180:183], v[124:127], a[140:143], v[180:183]
    v_mfma_f32_16x16x32_bf16 v[200:203], a[12:15], v[124:127], v[200:203]
    v_mfma_f32_16x16x32_bf16 v[164:167], a[76:79], v[128:131], v[164:167]
    v_mfma_f32_16x16x32_bf16 v[184:187], v[128:131], a[140:143], v[184:187]
    v_mfma_f32_16x16x32_bf16 v[204:207], a[12:15], v[128:131], v[204:207]
    v_mfma_f32_16x16x32_bf16 v[168:171], a[76:79], v[132:135], v[168:171]
    v_mfma_f32_16x16x32_bf16 v[188:191], v[132:135], a[140:143], v[188:191]
    v_mfma_f32_16x16x32_bf16 v[208:211], a[12:15], v[132:135], v[208:211]
    s_waitcnt lgkmcnt(0)
    v_mfma_f32_16x16x32_bf16 v[156:159], a[80:83], v[212:215], v[156:159]
    ds_read_b128 v[120:123], v6 offset:22528
    v_mfma_f32_16x16x32_bf16 v[176:179], v[212:215], a[144:147], v[176:179]
    ds_read_b128 v[124:127], v6 offset:24576
    v_mfma_f32_16x16x32_bf16 v[196:199], a[16:19], v[212:215], v[196:199]
    ds_read_b128 v[128:131], v6 offset:26624
    v_mfma_f32_16x16x32_bf16 v[160:163], a[80:83], v[216:219], v[160:163]
    ds_read_b128 v[132:135], v6 offset:28672
    v_mfma_f32_16x16x32_bf16 v[180:183], v[216:219], a[144:147], v[180:183]
    v_mfma_f32_16x16x32_bf16 v[200:203], a[16:19], v[216:219], v[200:203]
    v_mfma_f32_16x16x32_bf16 v[164:167], a[80:83], v[220:223], v[164:167]
    v_mfma_f32_16x16x32_bf16 v[184:187], v[220:223], a[144:147], v[184:187]
    v_mfma_f32_16x16x32_bf16 v[204:207], a[16:19], v[220:223], v[204:207]
    v_mfma_f32_16x16x32_bf16 v[168:171], a[80:83], v[224:227], v[168:171]
    v_mfma_f32_16x16x32_bf16 v[188:191], v[224:227], a[144:147], v[188:191]
    v_mfma_f32_16x16x32_bf16 v[208:211], a[16:19], v[224:227], v[208:211]
    s_waitcnt vmcnt(0) lgkmcnt(0)
    s_barrier
    v_mfma_f32_16x16x32_bf16 v[156:159], a[84:87], v[120:123], v[156:159]
    ds_read_b128 v[212:215], v5 offset:32768
    v_mfma_f32_16x16x32_bf16 v[176:179], v[120:123], a[148:151], v[176:179]
    ds_read_b128 v[216:219], v5 offset:34816
    v_mfma_f32_16x16x32_bf16 v[196:199], a[20:23], v[120:123], v[196:199]
    ds_read_b128 v[220:223], v5 offset:36864
    v_mfma_f32_16x16x32_bf16 v[160:163], a[84:87], v[124:127], v[160:163]
    ds_read_b128 v[224:227], v5 offset:38912
    v_mfma_f32_16x16x32_bf16 v[180:183], v[124:127], a[148:151], v[180:183]
    v_mfma_f32_16x16x32_bf16 v[200:203], a[20:23], v[124:127], v[200:203]
    v_mfma_f32_16x16x32_bf16 v[164:167], a[84:87], v[128:131], v[164:167]
    v_mfma_f32_16x16x32_bf16 v[184:187], v[128:131], a[148:151], v[184:187]
    v_mfma_f32_16x16x32_bf16 v[204:207], a[20:23], v[128:131], v[204:207]
    v_mfma_f32_16x16x32_bf16 v[168:171], a[84:87], v[132:135], v[168:171]
    v_mfma_f32_16x16x32_bf16 v[188:191], v[132:135], a[148:151], v[188:191]
    v_mfma_f32_16x16x32_bf16 v[208:211], a[20:23], v[132:135], v[208:211]
    s_waitcnt lgkmcnt(0)
    v_mfma_f32_16x16x32_bf16 v[156:159], a[88:91], v[212:215], v[156:159]
    ds_read_b128 v[120:123], v6 offset:32768
    v_mfma_f32_16x16x32_bf16 v[176:179], v[212:215], a[152:155], v[176:179]
    ds_read_b128 v[124:127], v6 offset:34816
    v_mfma_f32_16x16x32_bf16 v[196:199], a[24:27], v[212:215], v[196:199]
    ds_read_b128 v[128:131], v6 offset:36864
    v_mfma_f32_16x16x32_bf16 v[160:163], a[88:91], v[216:219], v[160:163]
    ds_read_b128 v[132:135], v6 offset:38912
    v_mfma_f32_16x16x32_bf16 v[180:183], v[216:219], a[152:155], v[180:183]
    v_mfma_f32_16x16x32_bf16 v[200:203], a[24:27], v[216:219], v[200:203]
    v_mfma_f32_16x16x32_bf16 v[164:167], a[88:91], v[220:223], v[164:167]
    v_mfma_f32_16x16x32_bf16 v[184:187], v[220:223], a[152:155], v[184:187]
    v_mfma_f32_16x16x32_bf16 v[204:207], a[24:27], v[220:223], v[204:207]
    v_mfma_f32_16x16x32_bf16 v[168:171], a[88:91], v[224:227], v[168:171]
    v_mfma_f32_16x16x32_bf16 v[188:191], v[224:227], a[152:155], v[188:191]
    v_mfma_f32_16x16x32_bf16 v[208:211], a[24:27], v[224:227], v[208:211]
    s_waitcnt lgkmcnt(0)
    buffer_load_dword v241, v240, s[20:23], s62 offen sc1
    v_mfma_f32_16x16x32_bf16 v[156:159], a[92:95], v[120:123], v[156:159]
    ds_read_b128 v[212:215], v7 offset:2048
    v_mfma_f32_16x16x32_bf16 v[176:179], v[120:123], a[156:159], v[176:179]
    ds_read_b128 v[216:219], v7 offset:4096
    v_mfma_f32_16x16x32_bf16 v[196:199], a[28:31], v[120:123], v[196:199]
    ds_read_b128 v[220:223], v7 offset:6144
    v_mfma_f32_16x16x32_bf16 v[160:163], a[92:95], v[124:127], v[160:163]
    ds_read_b128 v[224:227], v7 offset:8192
    v_mfma_f32_16x16x32_bf16 v[180:183], v[124:127], a[156:159], v[180:183]
    v_mfma_f32_16x16x32_bf16 v[200:203], a[28:31], v[124:127], v[200:203]
    v_mfma_f32_16x16x32_bf16 v[164:167], a[92:95], v[128:131], v[164:167]
    v_mfma_f32_16x16x32_bf16 v[184:187], v[128:131], a[156:159], v[184:187]
    v_mfma_f32_16x16x32_bf16 v[204:207], a[28:31], v[128:131], v[204:207]
    v_mfma_f32_16x16x32_bf16 v[168:171], a[92:95], v[132:135], v[168:171]
    v_mfma_f32_16x16x32_bf16 v[188:191], v[132:135], a[156:159], v[188:191]
    v_mfma_f32_16x16x32_bf16 v[208:211], a[28:31], v[132:135], v[208:211]
    s_waitcnt lgkmcnt(0)
    v_mfma_f32_16x16x32_bf16 v[156:159], a[96:99], v[212:215], v[156:159]
    ds_read_b128 v[120:123], v8 offset:2048
    v_mfma_f32_16x16x32_bf16 v[176:179], v[212:215], a[160:163], v[176:179]
    ds_read_b128 v[124:127], v8 offset:4096
    v_mfma_f32_16x16x32_bf16 v[196:199], a[32:35], v[212:215], v[196:199]
    ds_read_b128 v[128:131], v8 offset:6144
    v_mfma_f32_16x16x32_bf16 v[160:163], a[96:99], v[216:219], v[160:163]
    ds_read_b128 v[132:135], v8 offset:8192
    v_mfma_f32_16x16x32_bf16 v[180:183], v[216:219], a[160:163], v[180:183]
    v_mfma_f32_16x16x32_bf16 v[200:203], a[32:35], v[216:219], v[200:203]
    v_mfma_f32_16x16x32_bf16 v[164:167], a[96:99], v[220:223], v[164:167]
    v_mfma_f32_16x16x32_bf16 v[184:187], v[220:223], a[160:163], v[184:187]
    v_mfma_f32_16x16x32_bf16 v[204:207], a[32:35], v[220:223], v[204:207]
    v_mfma_f32_16x16x32_bf16 v[168:171], a[96:99], v[224:227], v[168:171]
    v_mfma_f32_16x16x32_bf16 v[188:191], v[224:227], a[160:163], v[188:191]
    v_mfma_f32_16x16x32_bf16 v[208:211], a[32:35], v[224:227], v[208:211]
    s_waitcnt lgkmcnt(0)
    s_cmp_eq_u32 s47, 0
    s_cbranch_scc1 LH_82
    s_waitcnt vmcnt(0)
    v_cmp_ne_u32 vcc, s49, v241
    s_cbranch_vccnz LH_83
LH_84:
    buffer_load_dwordx2 v[228:229], v230, s[20:23], s59 offen sc1
    s_lshl_b32 s78, s44, 1
    s_add_u32 s78, s78, 0
    s_mul_i32 s79, s78, 10240
    s_add_u32 m0, s79, 1024
    s_add_u32 s78, s78, s50
    s_and_b32 s78, s78, 7
    s_lshl_b32 s78, s78, 7
    s_add_u32 s78, s78, s76
    buffer_load_dwordx4 v4, s[20:23], s78 offen sc1 lds
    s_lshl_b32 s78, s44, 1
    s_add_u32 s78, s78, 1
    s_mul_i32 s79, s78, 10240
    s_add_u32 m0, s79, 1024
    s_add_u32 s78, s78, s50
    s_and_b32 s78, s78, 7
    s_lshl_b32 s78, s78, 7
    s_add_u32 s78, s78, s76
    buffer_load_dwordx4 v4, s[20:23], s78 offen sc1 lds
LH_82:
    s_cmp_eq_u32 s85, 0
    s_cbranch_scc1 LR_86
    buffer_load_dwordx4 v[136:139], v3, s[20:23], s99 offen sc1
    buffer_load_dwordx4 v[140:143], v3, s[20:23], s99 offen offset:1024 sc1
LR_86:
    s_cmp_lg_u32 s85, 0
    s_cbranch_scc1 LR_87
    s_mov_b32 s10, 1
    s_call_b64 s[0:1], L_OWN
LR_87:
    v_mfma_f32_16x16x32_bf16 v[156:159], a[100:103], v[120:123], v[156:159]
    ds_read_b128 v[212:215], v7 offset:12288
    v_mfma_f32_16x16x32_bf16 v[176:179], v[120:123], a[164:167], v[176:179]
    ds_read_b128 v[216:219], v7 offset:14336
    v_mfma_f32_16x16x32_bf16 v[196:199], a[36:39], v[120:123], v[196:199]
    ds_read_b128 v[220:223], v7 offset:16384
    v_mfma_f32_16x16x32_bf16 v[160:163], a[100:103], v[124:127], v[160:163]
    ds_read_b128 v[224:227], v7 offset:18432
    v_mfma_f32_16x16x32_bf16 v[180:183], v[124:127], a[164:167], v[180:183]
    v_mfma_f32_16x16x32_bf16 v[200:203], a[36:39], v[124:127], v[200:203]
    v_mfma_f32_16x16x32_bf16 v[164:167], a[100:103], v[128:131], v[164:167]
    v_mfma_f32_16x16x32_bf16 v[184:187], v[128:131], a[164:167], v[184:187]
    v_mfma_f32_16x16x32_bf16 v[204:207], a[36:39], v[128:131], v[204:207]
    v_mfma_f32_16x16x32_bf16 v[168:171], a[100:103], v[132:135], v[168:171]
    v_mfma_f32_16x16x32_bf16 v[188:191], v[132:135], a[164:167], v[188:191]
    v_mfma_f32_16x16x32_bf16 v[208:211], a[36:39], v[132:135], v[208:211]
    s_waitcnt lgkmcnt(0)
    v_mfma_f32_16x16x32_bf16 v[156:159], a[104:107], v[212:215], v[156:159]
    ds_read_b128 v[120:123], v8 offset:12288
    v_mfma_f32_16x16x32_bf16 v[176:179], v[212:215], a[168:171], v[176:179]
    ds_read_b128 v[124:127], v8 offset:14336
    v_mfma_f32_16x16x32_bf16 v[196:199], a[40:43], v[212:215], v[196:199]
    ds_read_b128 v[128:131], v8 offset:16384
    v_mfma_f32_16x16x32_bf16 v[160:163], a[104:107], v[216:219], v[160:163]
    ds_read_b128 v[132:135], v8 offset:18432
    v_mfma_f32_16x16x32_bf16 v[180:183], v[216:219], a[168:171], v[180:183]
    v_mfma_f32_16x16x32_bf16 v[200:203], a[40:43], v[216:219], v[200:203]
    v_mfma_f32_16x16x32_bf16 v[164:167], a[104:107], v[220:223], v[164:167]
    v_mfma_f32_16x16x32_bf16 v[184:187], v[220:223], a[168:171], v[184:187]
    v_mfma_f32_16x16x32_bf16 v[204:207], a[40:43], v[220:223], v[204:207]
    v_mfma_f32_16x16x32_bf16 v[168:171], a[104:107], v[224:227], v[168:171]
    v_mfma_f32_16x16x32_bf16 v[188:191], v[224:227], a[168:171], v[188:191]
    v_mfma_f32_16x16x32_bf16 v[208:211], a[40:43], v[224:227], v[208:211]
    s_waitcnt lgkmcnt(0)
    s_cmp_eq_u32 s10, 2
    s_mov_b32 s10, 0
    s_cbranch_scc0 LR_88
    s_call_b64 s[0:1], L_OWNR
LR_88:
    v_mfma_f32_16x16x32_bf16 v[156:159], a[108:111], v[120:123], v[156:159]
    ds_read_b128 v[212:215], v7 offset:22528
    v_mfma_f32_16x16x32_bf16 v[176:179], v[120:123], a[172:175], v[176:179]
    ds_read_b128 v[216:219], v7 offset:24576
    v_mfma_f32_16x16x32_bf16 v[196:199], a[44:47], v[120:123], v[196:199]
    ds_read_b128 v[220:223], v7 offset:26624
    v_mfma_f32_16x16x32_bf16 v[160:163], a[108:111], v[124:127], v[160:163]
    ds_read_b128 v[224:227], v7 offset:28672
    v_mfma_f32_16x16x32_bf16 v[180:183], v[124:127], a[172:175], v[180:183]
    v_mfma_f32_16x16x32_bf16 v[200:203], a[44:47], v[124:127], v[200:203]
    v_mfma_f32_16x16x32_bf16 v[164:167], a[108:111], v[128:131], v[164:167]
    v_mfma_f32_16x16x32_bf16 v[184:187], v[128:131], a[172:175], v[184:187]
    v_mfma_f32_16x16x32_bf16 v[204:207], a[44:47], v[128:131], v[204:207]
    v_mfma_f32_16x16x32_bf16 v[168:171], a[108:111], v[132:135], v[168:171]
    v_mfma_f32_16x16x32_bf16 v[188:191], v[132:135], a[172:175], v[188:191]
    v_mfma_f32_16x16x32_bf16 v[208:211], a[44:47], v[132:135], v[208:211]
    s_waitcnt lgkmcnt(0)
    v_mfma_f32_16x16x32_bf16 v[156:159], a[112:115], v[212:215], v[156:159]
    ds_read_b128 v[120:123], v8 offset:22528
    v_mfma_f32_16x16x32_bf16 v[176:179], v[212:215], a[176:179], v[176:179]
    ds_read_b128 v[124:127], v8 offset:24576
    v_mfma_f32_16x16x32_bf16 v[196:199], a[48:51], v[212:215], v[196:199]
    ds_read_b128 v[128:131], v8 offset:26624
    v_mfma_f32_16x16x32_bf16 v[160:163], a[112:115], v[216:219], v[160:163]
    ds_read_b128 v[132:135], v8 offset:28672
    v_mfma_f32_16x16x32_bf16 v[180:183], v[216:219], a[176:179], v[180:183]
    v_mfma_f32_16x16x32_bf16 v[200:203], a[48:51], v[216:219], v[200:203]
    v_mfma_f32_16x16x32_bf16 v[164:167], a[112:115], v[220:223], v[164:167]
    v_mfma_f32_16x16x32_bf16 v[184:187], v[220:223], a[176:179], v[184:187]
    v_mfma_f32_16x16x32_bf16 v[204:207], a[48:51], v[220:223], v[204:207]
    v_mfma_f32_16x16x32_bf16 v[168:171], a[112:115], v[224:227], v[168:171]
    v_mfma_f32_16x16x32_bf16 v[188:191], v[224:227], a[176:179], v[188:191]
    v_mfma_f32_16x16x32_bf16 v[208:211], a[48:51], v[224:227], v[208:211]
    s_waitcnt lgkmcnt(0)
    s_cmp_eq_u32 s47, 0
    s_waitcnt vmcnt(0)
    s_cbranch_scc1 LH_89
    ds_write2_b32 v13, v228, v229 offset0:0 offset1:80
LH_89:
    s_barrier
    v_cmp_ne_u32 vcc, s49, v138
    v_cmp_ne_u32 s[6:7], s49, v142
    s_nop 0
    s_or_b64 vcc, vcc, s[6:7]
    s_cmp_eq_u64 vcc, 0
    s_cselect_b32 s86, 1, 0
    v_mfma_f32_16x16x32_bf16 v[156:159], a[116:119], v[120:123], v[156:159]
    ds_read_b128 v[212:215], v7 offset:32768
    v_max_u32 v144, v136, v140
    v_mfma_f32_16x16x32_bf16 v[176:179], v[120:123], a[180:183], v[176:179]
    ds_read_b128 v[216:219], v7 offset:34816
    v_min_u32 v148, v136, v140
    v_mfma_f32_16x16x32_bf16 v[196:199], a[52:55], v[120:123], v[196:199]
    ds_read_b128 v[220:223], v7 offset:36864
    v_mov_b32 v146, v144
    v_mfma_f32_16x16x32_bf16 v[160:163], a[116:119], v[124:127], v[160:163]
    ds_read_b128 v[224:227], v7 offset:38912
    v_max3_u32 v145, v148, v137, v141
    v_mfma_f32_16x16x32_bf16 v[180:183], v[124:127], a[180:183], v[180:183]
    v_mov_b32 v147, v145
    v_mfma_f32_16x16x32_bf16 v[200:203], a[52:55], v[124:127], v[200:203]
    v_permlane32_swap_b32 v144, v146
    v_mfma_f32_16x16x32_bf16 v[164:167], a[116:119], v[128:131], v[164:167]
    v_permlane32_swap_b32 v145, v147
    v_mfma_f32_16x16x32_bf16 v[184:187], v[128:131], a[180:183], v[184:187]
    v_min_u32 v148, v144, v146
    v_mfma_f32_16x16x32_bf16 v[204:207], a[52:55], v[128:131], v[204:207]
    v_max_u32 v144, v144, v146
    v_mfma_f32_16x16x32_bf16 v[168:171], a[116:119], v[132:135], v[168:171]
    v_max3_u32 v145, v145, v147, v148
    v_mfma_f32_16x16x32_bf16 v[188:191], v[132:135], a[180:183], v[188:191]
    v_mov_b32 v146, v144
    v_mfma_f32_16x16x32_bf16 v[208:211], a[52:55], v[132:135], v[208:211]
    v_mov_b32 v147, v145
    v_permlane16_swap_b32 v144, v146
    s_nop 0
    v_permlane16_swap_b32 v145, v147
    s_waitcnt lgkmcnt(0)
    s_cmp_lt_i32 s54, 0
    s_cbranch_scc1 LH_90
    buffer_load_dwordx4 v[152:155], v3, s[20:23], s52 offen sc1
LH_90:
    v_mfma_f32_16x16x32_bf16 v[156:159], a[120:123], v[212:215], v[156:159]
    ds_read_b128 v[120:123], v8 offset:32768
    v_min_u32 v148, v144, v146
    v_mfma_f32_16x16x32_bf16 v[176:179], v[212:215], a[184:187], v[176:179]
    ds_read_b128 v[124:127], v8 offset:34816
    v_max_u32 v144, v144, v146
    v_mfma_f32_16x16x32_bf16 v[196:199], a[56:59], v[212:215], v[196:199]
    ds_read_b128 v[128:131], v8 offset:36864
    v_max3_u32 v145, v145, v147, v148
    v_mfma_f32_16x16x32_bf16 v[160:163], a[120:123], v[216:219], v[160:163]
    ds_read_b128 v[132:135], v8 offset:38912
    v_min_u32_dpp v148, v144, v144 row_ror:8 row_mask:0xf bank_mask:0xf
    v_mfma_f32_16x16x32_bf16 v[180:183], v[216:219], a[184:187], v[180:183]
    v_max_u32_dpp v147, v145, v145 row_ror:8 row_mask:0xf bank_mask:0xf
    v_mfma_f32_16x16x32_bf16 v[200:203], a[56:59], v[216:219], v[200:203]
    v_max_u32_dpp v144, v144, v144 row_ror:8 row_mask:0xf bank_mask:0xf
    v_mfma_f32_16x16x32_bf16 v[164:167], a[120:123], v[220:223], v[164:167]
    v_max_u32 v145, v147, v148
    v_mfma_f32_16x16x32_bf16 v[184:187], v[220:223], a[184:187], v[184:187]
    v_min_u32_dpp v148, v144, v144 row_ror:4 row_mask:0xf bank_mask:0xf
    v_mfma_f32_16x16x32_bf16 v[204:207], a[56:59], v[220:223], v[204:207]
    v_max_u32_dpp v147, v145, v145 row_ror:4 row_mask:0xf bank_mask:0xf
    v_mfma_f32_16x16x32_bf16 v[168:171], a[120:123], v[224:227], v[168:171]
    v_max_u32_dpp v144, v144, v144 row_ror:4 row_mask:0xf bank_mask:0xf
    v_mfma_f32_16x16x32_bf16 v[188:191], v[224:227], a[184:187], v[188:191]
    v_max_u32 v145, v147, v148
    v_mfma_f32_16x16x32_bf16 v[208:211], a[56:59], v[224:227], v[208:211]
    v_min_u32_dpp v148, v144, v144 row_ror:2 row_mask:0xf bank_mask:0xf
    v_max_u32_dpp v147, v145, v145 row_ror:2 row_mask:0xf bank_mask:0xf
    v_max_u32_dpp v144, v144, v144 row_ror:2 row_mask:0xf bank_mask:0xf
    v_max_u32 v145, v147, v148
    s_nop 0
    v_min_u32_dpp v148, v144, v144 row_ror:1 row_mask:0xf bank_mask:0xf
    v_max_u32_dpp v147, v145, v145 row_ror:1 row_mask:0xf bank_mask:0xf
    v_max_u32_dpp v144, v144, v144 row_ror:1 row_mask:0xf bank_mask:0xf
    v_max_u32 v145, v147, v148
    s_waitcnt lgkmcnt(0)
    s_cmp_lt_i32 s54, 0
    s_cbranch_scc1 LK_92
    s_cmp_eq_u32 s75, 0
    s_cbranch_scc1 LK_91
    s_call_b64 s[0:1], L_FIXA
    s_branch LK_91
LK_92:
    v_readfirstlane_b32 s81, v144
    v_readfirstlane_b32 s82, v145
    s_cmp_eq_u32 s86, 0
    s_cbranch_scc1 LK_91
    s_call_b64 s[0:1], L_OWN
    s_mov_b32 s85, 0
LK_91:
    v_mfma_f32_16x16x32_bf16 v[156:159], a[124:127], v[120:123], v[156:159]
    ds_read_b128 v[136:139], v5 offset:0
    v_mfma_f32_16x16x32_bf16 v[176:179], v[120:123], a[188:191], v[176:179]
    ds_read_b128 v[140:143], v6 offset:0
    v_mfma_f32_16x16x32_bf16 v[196:199], a[60:63], v[120:123], v[196:199]
    ds_read_b128 v[144:147], v5 offset:10240
    v_mfma_f32_16x16x32_bf16 v[160:163], a[124:127], v[124:127], v[160:163]
    ds_read_b128 v[212:215], v6 offset:10240
    v_mfma_f32_16x16x32_bf16 v[180:183], v[124:127], a[188:191], v[180:183]
    ds_read2_b32 v[148:149], v13 offset0:16 offset1:96
    v_mfma_f32_16x16x32_bf16 v[200:203], a[60:63], v[124:127], v[200:203]
    ds_read_b128 v[220:223], v14 offset:64
    v_mfma_f32_16x16x32_bf16 v[164:167], a[124:127], v[128:131], v[164:167]
    ds_read_b128 v[224:227], v14 offset:384
    v_mfma_f32_16x16x32_bf16 v[184:187], v[128:131], a[188:191], v[184:187]
    ds_read2_b32 v[150:151], v13 offset0:32 offset1:112
    v_mfma_f32_16x16x32_bf16 v[204:207], a[60:63], v[128:131], v[204:207]
    ds_read_b128 v[228:231], v14 offset:128
    v_mfma_f32_16x16x32_bf16 v[168:171], a[124:127], v[132:135], v[168:171]
    ds_read_b128 v[232:235], v14 offset:448
    v_mfma_f32_16x16x32_bf16 v[188:191], v[132:135], a[188:191], v[188:191]
    v_mfma_f32_16x16x32_bf16 v[208:211], a[60:63], v[132:135], v[208:211]
    ds_read2_b32 v[194:195], v13 offset0:48 offset1:128
    ds_read_b128 v[236:239], v14 offset:192
    ds_read_b128 v[240:243], v14 offset:512
    ds_read2_b32 v[252:253], v13 offset0:64 offset1:144
    ds_read_b128 v[244:247], v14 offset:256
    ds_read_b128 v[248:251], v14 offset:576
    s_waitcnt lgkmcnt(0)
    v_pk_fma_f32 v[156:157], v[20:21], v[148:149], v[156:157] op_sel_hi:[1,0,1] neg_lo:[0,1,0] neg_hi:[0,1,0]
    v_pk_fma_f32 v[158:159], v[22:23], v[148:149], v[158:159] op_sel_hi:[1,0,1] neg_lo:[0,1,0] neg_hi:[0,1,0]
    v_pk_fma_f32 v[176:177], v[220:221], v[24:25], v[176:177] op_sel_hi:[1,0,1] neg_lo:[0,1,0] neg_hi:[0,1,0]
    v_pk_fma_f32 v[178:179], v[222:223], v[24:25], v[178:179] op_sel_hi:[1,0,1] neg_lo:[0,1,0] neg_hi:[0,1,0]
    v_pk_fma_f32 v[196:197], v[16:17], v[148:149], v[196:197] op_sel_hi:[1,0,1] neg_lo:[0,1,0] neg_hi:[0,1,0]
    v_pk_fma_f32 v[198:199], v[18:19], v[148:149], v[198:199] op_sel_hi:[1,0,1] neg_lo:[0,1,0] neg_hi:[0,1,0]
    v_pk_mul_f32 v[156:157], v[156:157], v[148:149] op_sel:[0,1] op_sel_hi:[1,1]
    v_pk_mul_f32 v[158:159], v[158:159], v[148:149] op_sel:[0,1] op_sel_hi:[1,1]
    v_pk_mul_f32 v[176:177], v[176:177], v[224:225]
    v_pk_mul_f32 v[178:179], v[178:179], v[226:227]
    v_pk_fma_f32 v[160:161], v[20:21], v[150:151], v[160:161] op_sel_hi:[1,0,1] neg_lo:[0,1,0] neg_hi:[0,1,0]
    v_pk_fma_f32 v[162:163], v[22:23], v[150:151], v[162:163] op_sel_hi:[1,0,1] neg_lo:[0,1,0] neg_hi:[0,1,0]
    v_pk_fma_f32 v[180:181], v[228:229], v[24:25], v[180:181] op_sel_hi:[1,0,1] neg_lo:[0,1,0] neg_hi:[0,1,0]
    v_pk_fma_f32 v[182:183], v[230:231], v[24:25], v[182:183] op_sel_hi:[1,0,1] neg_lo:[0,1,0] neg_hi:[0,1,0]
    v_pk_fma_f32 v[200:201], v[16:17], v[150:151], v[200:201] op_sel_hi:[1,0,1] neg_lo:[0,1,0] neg_hi:[0,1,0]
    v_pk_fma_f32 v[202:203], v[18:19], v[150:151], v[202:203] op_sel_hi:[1,0,1] neg_lo:[0,1,0] neg_hi:[0,1,0]
    v_pk_mul_f32 v[160:161], v[160:161], v[150:151] op_sel:[0,1] op_sel_hi:[1,1]
    v_pk_mul_f32 v[162:163], v[162:163], v[150:151] op_sel:[0,1] op_sel_hi:[1,1]
    v_pk_mul_f32 v[180:181], v[180:181], v[232:233]
    v_pk_mul_f32 v[182:183], v[182:183], v[234:235]
    v_pk_fma_f32 v[164:165], v[20:21], v[194:195], v[164:165] op_sel_hi:[1,0,1] neg_lo:[0,1,0] neg_hi:[0,1,0]
    v_pk_fma_f32 v[166:167], v[22:23], v[194:195], v[166:167] op_sel_hi:[1,0,1] neg_lo:[0,1,0] neg_hi:[0,1,0]
    v_pk_fma_f32 v[184:185], v[236:237], v[24:25], v[184:185] op_sel_hi:[1,0,1] neg_lo:[0,1,0] neg_hi:[0,1,0]
    v_pk_fma_f32 v[186:187], v[238:239], v[24:25], v[186:187] op_sel_hi:[1,0,1] neg_lo:[0,1,0] neg_hi:[0,1,0]
    v_pk_fma_f32 v[204:205], v[16:17], v[194:195], v[204:205] op_sel_hi:[1,0,1] neg_lo:[0,1,0] neg_hi:[0,1,0]
    v_pk_fma_f32 v[206:207], v[18:19], v[194:195], v[206:207] op_sel_hi:[1,0,1] neg_lo:[0,1,0] neg_hi:[0,1,0]
    v_pk_mul_f32 v[164:165], v[164:165], v[194:195] op_sel:[0,1] op_sel_hi:[1,1]
    v_pk_mul_f32 v[166:167], v[166:167], v[194:195] op_sel:[0,1] op_sel_hi:[1,1]
    v_pk_mul_f32 v[184:185], v[184:185], v[240:241]
    v_pk_mul_f32 v[186:187], v[186:187], v[242:243]
    v_pk_fma_f32 v[168:169], v[20:21], v[252:253], v[168:169] op_sel_hi:[1,0,1] neg_lo:[0,1,0] neg_hi:[0,1,0]
    v_pk_fma_f32 v[170:171], v[22:23], v[252:253], v[170:171] op_sel_hi:[1,0,1] neg_lo:[0,1,0] neg_hi:[0,1,0]
    v_pk_fma_f32 v[188:189], v[244:245], v[24:25], v[188:189] op_sel_hi:[1,0,1] neg_lo:[0,1,0] neg_hi:[0,1,0]
    v_pk_fma_f32 v[190:191], v[246:247], v[24:25], v[190:191] op_sel_hi:[1,0,1] neg_lo:[0,1,0] neg_hi:[0,1,0]
    v_pk_fma_f32 v[208:209], v[16:17], v[252:253], v[208:209] op_sel_hi:[1,0,1] neg_lo:[0,1,0] neg_hi:[0,1,0]
    v_pk_fma_f32 v[210:211], v[18:19], v[252:253], v[210:211] op_sel_hi:[1,0,1] neg_lo:[0,1,0] neg_hi:[0,1,0]
    v_pk_mul_f32 v[168:169], v[168:169], v[252:253] op_sel:[0,1] op_sel_hi:[1,1]
    v_pk_mul_f32 v[170:171], v[170:171], v[252:253] op_sel:[0,1] op_sel_hi:[1,1]
    v_pk_mul_f32 v[188:189], v[188:189], v[248:249]
    v_pk_mul_f32 v[190:191], v[190:191], v[250:251]
    s_cmp_lt_i32 s54, 0
    s_cbranch_scc1 LK_93
    s_waitcnt vmcnt(0)
    v_max3_u32 v172, v152, v153, v154
    v_max_u32 v172, v172, v155
    v_cmp_eq_u32 vcc, -1, v172
    s_cbranch_vccnz LK_93
    v_mul_f32 v148, s90, v149
    v_cvt_pk_bf16_f32 v120, v196, v197
    v_cvt_pk_bf16_f32 v121, v198, v199
    v_cvt_pk_bf16_f32 v130, v156, v157
    v_cvt_pk_bf16_f32 v131, v158, v159
    v_mul_f32 v149, s90, v151
    v_cvt_pk_bf16_f32 v122, v200, v201
    v_cvt_pk_bf16_f32 v123, v202, v203
    v_cvt_pk_bf16_f32 v132, v160, v161
    v_cvt_pk_bf16_f32 v133, v162, v163
    v_mul_f32 v150, s90, v195
    v_cvt_pk_bf16_f32 v124, v204, v205
    v_cvt_pk_bf16_f32 v125, v206, v207
    v_cvt_pk_bf16_f32 v134, v164, v165
    v_cvt_pk_bf16_f32 v135, v166, v167
    v_mul_f32 v151, s90, v253
    v_cvt_pk_bf16_f32 v126, v208, v209
    v_cvt_pk_bf16_f32 v127, v210, v211
    v_cvt_pk_bf16_f32 v140, v176, v177
    v_cvt_pk_bf16_f32 v141, v178, v179
    v_cvt_pk_bf16_f32 v142, v180, v181
    v_cvt_pk_bf16_f32 v143, v182, v183
    v_cvt_pk_bf16_f32 v144, v184, v185
    v_cvt_pk_bf16_f32 v145, v186, v187
    v_cvt_pk_bf16_f32 v136, v168, v169
    v_cvt_pk_bf16_f32 v137, v170, v171
    v_cvt_pk_bf16_f32 v146, v188, v189
    v_cvt_pk_bf16_f32 v147, v190, v191
    v_mov_b32 v128, v152
    v_mov_b32 v129, v153
    v_mov_b32 v138, v154
    v_mov_b32 v139, v155
    s_branch LK_94
LK_93:
    v_mfma_f32_16x16x32_bf16 v[152:155], a[64:67], v[136:139], 0
    ds_read_b128 v[216:219], v5 offset:20480
    v_mfma_f32_16x16x32_bf16 v[172:175], v[136:139], a[128:131], 0
    v_mul_f32 v148, s90, v149
    s_waitcnt lgkmcnt(3)
    v_mfma_f32_16x16x32_bf16 v[152:155], a[68:71], v[140:143], v[152:155]
    ds_read_b128 v[136:139], v6 offset:20480
    v_mfma_f32_16x16x32_bf16 v[172:175], v[140:143], a[132:135], v[172:175]
    v_cvt_pk_bf16_f32 v120, v196, v197
    s_waitcnt lgkmcnt(3)
    v_mfma_f32_16x16x32_bf16 v[152:155], a[72:75], v[144:147], v[152:155]
    ds_read_b128 v[140:143], v5 offset:30720
    v_mfma_f32_16x16x32_bf16 v[172:175], v[144:147], a[136:139], v[172:175]
    v_cvt_pk_bf16_f32 v121, v198, v199
    s_waitcnt lgkmcnt(3)
    v_mfma_f32_16x16x32_bf16 v[152:155], a[76:79], v[212:215], v[152:155]
    ds_read_b128 v[144:147], v6 offset:30720
    v_mfma_f32_16x16x32_bf16 v[172:175], v[212:215], a[140:143], v[172:175]
    v_cvt_pk_bf16_f32 v130, v156, v157
    s_waitcnt lgkmcnt(3)
    v_mfma_f32_16x16x32_bf16 v[152:155], a[80:83], v[216:219], v[152:155]
    ds_read_b128 v[212:215], v7 offset:0
    v_mfma_f32_16x16x32_bf16 v[172:175], v[216:219], a[144:147], v[172:175]
    v_cvt_pk_bf16_f32 v131, v158, v159
    s_waitcnt lgkmcnt(3)
    v_mfma_f32_16x16x32_bf16 v[152:155], a[84:87], v[136:139], v[152:155]
    ds_read_b128 v[216:219], v8 offset:0
    v_mfma_f32_16x16x32_bf16 v[172:175], v[136:139], a[148:151], v[172:175]
    v_mul_f32 v149, s90, v151
    s_waitcnt lgkmcnt(3)
    v_mfma_f32_16x16x32_bf16 v[152:155], a[88:91], v[140:143], v[152:155]
    ds_read_b128 v[136:139], v7 offset:10240
    v_mfma_f32_16x16x32_bf16 v[172:175], v[140:143], a[152:155], v[172:175]
    v_cvt_pk_bf16_f32 v122, v200, v201
    s_waitcnt lgkmcnt(3)
    v_mfma_f32_16x16x32_bf16 v[152:155], a[92:95], v[144:147], v[152:155]
    ds_read_b128 v[140:143], v8 offset:10240
    v_mfma_f32_16x16x32_bf16 v[172:175], v[144:147], a[156:159], v[172:175]
    v_cvt_pk_bf16_f32 v123, v202, v203
    s_waitcnt lgkmcnt(3)
    v_mfma_f32_16x16x32_bf16 v[152:155], a[96:99], v[212:215], v[152:155]
    ds_read_b128 v[144:147], v7 offset:20480
    v_mfma_f32_16x16x32_bf16 v[172:175], v[212:215], a[160:163], v[172:175]
    v_cvt_pk_bf16_f32 v132, v160, v161
    s_waitcnt lgkmcnt(3)
    v_mfma_f32_16x16x32_bf16 v[152:155], a[100:103], v[216:219], v[152:155]
    ds_read_b128 v[212:215], v8 offset:20480
    v_mfma_f32_16x16x32_bf16 v[172:175], v[216:219], a[164:167], v[172:175]
    v_cvt_pk_bf16_f32 v133, v162, v163
    s_waitcnt lgkmcnt(3)
    v_mfma_f32_16x16x32_bf16 v[152:155], a[104:107], v[136:139], v[152:155]
    ds_read_b128 v[216:219], v7 offset:30720
    v_mul_f32 v150, s90, v195
    v_mfma_f32_16x16x32_bf16 v[172:175], v[136:139], a[168:171], v[172:175]
    v_cvt_pk_bf16_f32 v124, v204, v205
    s_waitcnt lgkmcnt(3)
    v_mfma_f32_16x16x32_bf16 v[152:155], a[108:111], v[140:143], v[152:155]
    ds_read_b128 v[136:139], v8 offset:30720
    v_cvt_pk_bf16_f32 v125, v206, v207
    v_mfma_f32_16x16x32_bf16 v[172:175], v[140:143], a[172:175], v[172:175]
    v_cvt_pk_bf16_f32 v134, v164, v165
    s_waitcnt lgkmcnt(3)
    v_mfma_f32_16x16x32_bf16 v[152:155], a[112:115], v[144:147], v[152:155]
    v_cvt_pk_bf16_f32 v135, v166, v167
    v_mfma_f32_16x16x32_bf16 v[172:175], v[144:147], a[176:179], v[172:175]
    v_mul_f32 v151, s90, v253
    s_waitcnt lgkmcnt(2)
    v_mfma_f32_16x16x32_bf16 v[152:155], a[116:119], v[212:215], v[152:155]
    v_cvt_pk_bf16_f32 v126, v208, v209
    v_mfma_f32_16x16x32_bf16 v[172:175], v[212:215], a[180:183], v[172:175]
    v_cvt_pk_bf16_f32 v127, v210, v211
    s_waitcnt lgkmcnt(1)
    v_mfma_f32_16x16x32_bf16 v[152:155], a[120:123], v[216:219], v[152:155]
    v_mfma_f32_16x16x32_bf16 v[172:175], v[216:219], a[184:187], v[172:175]
    s_waitcnt lgkmcnt(0)
    v_mfma_f32_16x16x32_bf16 v[152:155], a[124:127], v[136:139], v[152:155]
    v_mfma_f32_16x16x32_bf16 v[172:175], v[136:139], a[188:191], v[172:175]
    ds_read2_b32 v[192:193], v13 offset0:0 offset1:80
    ds_read_b128 v[212:215], v14 offset:0
    ds_read_b128 v[216:219], v14 offset:320
    v_cvt_pk_bf16_f32 v140, v176, v177
    v_cvt_pk_bf16_f32 v141, v178, v179
    v_cvt_pk_bf16_f32 v142, v180, v181
    v_cvt_pk_bf16_f32 v143, v182, v183
    v_cvt_pk_bf16_f32 v144, v184, v185
    v_cvt_pk_bf16_f32 v145, v186, v187
    v_cvt_pk_bf16_f32 v136, v168, v169
    v_cvt_pk_bf16_f32 v137, v170, v171
    v_cvt_pk_bf16_f32 v146, v188, v189
    v_cvt_pk_bf16_f32 v147, v190, v191
    s_waitcnt lgkmcnt(0)
    v_pk_fma_f32 v[152:153], v[20:21], v[192:193], v[152:153] op_sel_hi:[1,0,1] neg_lo:[0,1,0] neg_hi:[0,1,0]
    v_pk_fma_f32 v[154:155], v[22:23], v[192:193], v[154:155] op_sel_hi:[1,0,1] neg_lo:[0,1,0] neg_hi:[0,1,0]
    v_pk_fma_f32 v[172:173], v[212:213], v[24:25], v[172:173] op_sel_hi:[1,0,1] neg_lo:[0,1,0] neg_hi:[0,1,0]
    v_pk_fma_f32 v[174:175], v[214:215], v[24:25], v[174:175] op_sel_hi:[1,0,1] neg_lo:[0,1,0] neg_hi:[0,1,0]
    v_pk_mul_f32 v[152:153], v[152:153], v[192:193] op_sel:[0,1] op_sel_hi:[1,1]
    v_pk_mul_f32 v[154:155], v[154:155], v[192:193] op_sel:[0,1] op_sel_hi:[1,1]
    v_pk_mul_f32 v[172:173], v[172:173], v[216:217]
    v_pk_mul_f32 v[174:175], v[174:175], v[218:219]
    v_cvt_pk_bf16_f32 v128, v152, v153
    v_cvt_pk_bf16_f32 v129, v154, v155
    v_cvt_pk_bf16_f32 v138, v172, v173
    v_cvt_pk_bf16_f32 v139, v174, v175
    s_lshr_b32 s61, s2, 6
    s_cmp_lg_u32 s61, 0
    s_cbranch_scc1 LK_94
    v_mov_b32 v244, v136
    v_mov_b32 v245, v137
    v_mov_b32 v246, v146
    v_mov_b32 v247, v147
    buffer_store_dwordx4 v[244:247], v3, s[20:23], s52 offen sc1
LK_94:
L_POST1:
    s_cmp_ge_i32 s54, 0
    s_cbranch_scc1 LM_53
    s_cmp_lg_u32 s86, 0
    s_cbranch_scc1 LM_53
    s_lshl_b32 s56, s53, 3
    s_add_u32 s56, s56, s46
    s_lshl_b32 s56, s56, 7
    s_add_u32 s56, s56, 28672
    s_mov_b32 s80, 0x100000
LP_96:
    buffer_load_dwordx4 v[152:155], off, s[20:23], s56 sc1
    s_waitcnt vmcnt(0)
    v_cmp_ne_u32 vcc, s49, v154
    s_cbranch_vccnz LP_97
LP_98:
    v_readfirstlane_b32 s81, v152
    v_readfirstlane_b32 s82, v153
LM_53:
    s_cmp_eq_u32 s85, 0
    s_cbranch_scc1 LM_99
    s_call_b64 s[0:1], L_OWN
LM_99:
    s_cmp_lg_u32 s53, 0
    s_cbranch_scc1 L_DONE
    s_cmp_ge_i32 s54, 0
    s_cbranch_scc1 LZ_100
    s_call_b64 s[0:1], L_AFF
    s_cbranch_scc0 L_NEXT
    s_call_b64 s[0:1], L_FIXA
LZ_100:
    s_mov_b32 s86, s75
    s_cmp_eq_u32 s75, 0
    s_cbranch_scc1 L_NEXT
    s_cmp_lt_i32 s73, 0
    s_cbranch_scc1 LZ_101
    s_waitcnt vmcnt(0)
    v_max3_u32 v77, v72, v73, v74
    v_max_u32 v77, v77, v75
    v_cmp_eq_u32 vcc, -1, v77
    s_cbranch_vccnz LP_103
LP_104:
    ds_write_b128 v80, v[72:75] offset:0
    v_dot2c_f32_bf16 v76, v72, v44
    v_dot2c_f32_bf16 v78, v72, v72
    v_dot2c_f32_bf16 v76, v73, v44
    v_dot2c_f32_bf16 v78, v73, v73
    v_dot2c_f32_bf16 v76, v74, v44
    v_dot2c_f32_bf16 v78, v74, v74
    v_dot2c_f32_bf16 v76, v75, v44
    v_dot2c_f32_bf16 v78, v75, v75
    s_nop 1
    v_add_f32_dpp v76, v76, v76 row_ror:8 row_mask:0xf bank_mask:0xf
    v_add_f32_dpp v78, v78, v78 row_ror:8 row_mask:0xf bank_mask:0xf
    s_nop 0
    v_add_f32_dpp v76, v76, v76 row_ror:4 row_mask:0xf bank_mask:0xf
    v_add_f32_dpp v78, v78, v78 row_ror:4 row_mask:0xf bank_mask:0xf
    s_nop 0
    v_add_f32_dpp v76, v76, v76 row_ror:2 row_mask:0xf bank_mask:0xf
    v_add_f32_dpp v78, v78, v78 row_ror:2 row_mask:0xf bank_mask:0xf
    s_nop 0
    v_add_f32_dpp v76, v76, v76 row_ror:1 row_mask:0xf bank_mask:0xf
    v_add_f32_dpp v78, v78, v78 row_ror:1 row_mask:0xf bank_mask:0xf
    v_mov_b32 v82, v76
    v_mov_b32 v83, v78
    s_nop 0
    v_permlane32_swap_b32 v76, v82
    v_permlane32_swap_b32 v78, v83
    v_add_f32 v76, v76, v82
    v_add_f32 v78, v78, v83
    v_mov_b32 v82, v76
    v_mov_b32 v83, v78
    s_nop 0
    v_permlane16_swap_b32 v76, v82
    v_permlane16_swap_b32 v78, v83
    v_add_f32 v76, v76, v82
    v_add_f32 v78, v78, v83
    v_mul_f32 v84, s88, v76
    v_mul_f32 v78, s88, v78
    v_fma_f32 v78, -v84, v84, v78
    v_max_f32 v78, 0, v78
    v_add_f32 v85, s89, v78
    v_rsq_f32 v85, v85
    ds_write2_b32 v81, v84, v85 offset0:0 offset1:80
LZ_101:
    s_waitcnt vmcnt(0) lgkmcnt(0)
    s_barrier
L_QKV:
    s_ff1_i32_b32 s61, s86
    s_bitset0_b32 s86, s61
    s_lshl_b32 s56, s61, 11
    v_add_u32 v152, s56, v5
    v_add_u32 v153, s56, v6
    v_add_u32 v154, s56, v7
    v_add_u32 v155, s56, v8
    s_lshl_b32 s56, s61, 6
    ds_read_b128 v[168:171], v152 offset:0
    ds_read_b128 v[172:175], v153 offset:0
    ds_read_b128 v[176:179], v152 offset:10240
    ds_read_b128 v[180:183], v153 offset:10240
    ds_read_b128 v[184:187], v152 offset:20480
    v_add_u32 v204, s56, v13
    v_add_u32 v205, s56, v14
    s_waitcnt lgkmcnt(4)
    v_mfma_f32_16x16x32_bf16 v[196:199], a[64:67], v[168:171], 0
    ds_read_b128 v[188:191], v153 offset:20480
    v_mfma_f32_16x16x32_bf16 v[200:203], v[168:171], a[128:131], 0
    v_mfma_f32_16x16x32_bf16 v[192:195], a[0:3], v[168:171], 0
    s_waitcnt lgkmcnt(4)
    v_mfma_f32_16x16x32_bf16 v[196:199], a[68:71], v[172:175], v[196:199]
    ds_read_b128 v[168:171], v152 offset:30720
    v_mfma_f32_16x16x32_bf16 v[200:203], v[172:175], a[132:135], v[200:203]
    v_mfma_f32_16x16x32_bf16 v[192:195], a[4:7], v[172:175], v[192:195]
    s_waitcnt lgkmcnt(4)
    v_mfma_f32_16x16x32_bf16 v[196:199], a[72:75], v[176:179], v[196:199]
    ds_read_b128 v[172:175], v153 offset:30720
    v_mfma_f32_16x16x32_bf16 v[200:203], v[176:179], a[136:139], v[200:203]
    v_mfma_f32_16x16x32_bf16 v[192:195], a[8:11], v[176:179], v[192:195]
    s_waitcnt lgkmcnt(4)
    v_mfma_f32_16x16x32_bf16 v[196:199], a[76:79], v[180:183], v[196:199]
    ds_read_b128 v[176:179], v154 offset:0
    v_mfma_f32_16x16x32_bf16 v[200:203], v[180:183], a[140:143], v[200:203]
    v_mfma_f32_16x16x32_bf16 v[192:195], a[12:15], v[180:183], v[192:195]
    s_waitcnt lgkmcnt(4)
    v_mfma_f32_16x16x32_bf16 v[196:199], a[80:83], v[184:187], v[196:199]
    ds_read_b128 v[180:183], v155 offset:0
    v_mfma_f32_16x16x32_bf16 v[200:203], v[184:187], a[144:147], v[200:203]
    v_mfma_f32_16x16x32_bf16 v[192:195], a[16:19], v[184:187], v[192:195]
    s_waitcnt lgkmcnt(4)
    v_mfma_f32_16x16x32_bf16 v[196:199], a[84:87], v[188:191], v[196:199]
    ds_read_b128 v[184:187], v154 offset:10240
    v_mfma_f32_16x16x32_bf16 v[200:203], v[188:191], a[148:151], v[200:203]
    v_mfma_f32_16x16x32_bf16 v[192:195], a[20:23], v[188:191], v[192:195]
    s_waitcnt lgkmcnt(4)
    v_mfma_f32_16x16x32_bf16 v[196:199], a[88:91], v[168:171], v[196:199]
    ds_read_b128 v[188:191], v155 offset:10240
    v_mfma_f32_16x16x32_bf16 v[200:203], v[168:171], a[152:155], v[200:203]
    v_mfma_f32_16x16x32_bf16 v[192:195], a[24:27], v[168:171], v[192:195]
    s_waitcnt lgkmcnt(4)
    v_mfma_f32_16x16x32_bf16 v[196:199], a[92:95], v[172:175], v[196:199]
    ds_read_b128 v[168:171], v154 offset:20480
    v_mfma_f32_16x16x32_bf16 v[200:203], v[172:175], a[156:159], v[200:203]
    v_mfma_f32_16x16x32_bf16 v[192:195], a[28:31], v[172:175], v[192:195]
    s_waitcnt lgkmcnt(4)
    v_mfma_f32_16x16x32_bf16 v[196:199], a[96:99], v[176:179], v[196:199]
    ds_read_b128 v[172:175], v155 offset:20480
    v_mfma_f32_16x16x32_bf16 v[200:203], v[176:179], a[160:163], v[200:203]
    v_mfma_f32_16x16x32_bf16 v[192:195], a[32:35], v[176:179], v[192:195]
    s_waitcnt lgkmcnt(4)
    v_mfma_f32_16x16x32_bf16 v[196:199], a[100:103], v[180:183], v[196:199]
    ds_read_b128 v[176:179], v154 offset:30720
    v_mfma_f32_16x16x32_bf16 v[200:203], v[180:183], a[164:167], v[200:203]
    v_mfma_f32_16x16x32_bf16 v[192:195], a[36:39], v[180:183], v[192:195]
    s_waitcnt lgkmcnt(4)
    v_mfma_f32_16x16x32_bf16 v[196:199], a[104:107], v[184:187], v[196:199]
    ds_read_b128 v[180:183], v155 offset:30720
    ds_read2_b32 v[156:157], v204 offset0:0 offset1:80
    ds_read_b128 v[160:163], v205
    ds_read_b128 v[164:167], v205 offset:320
    v_mfma_f32_16x16x32_bf16 v[200:203], v[184:187], a[168:171], v[200:203]
    v_mfma_f32_16x16x32_bf16 v[192:195], a[40:43], v[184:187], v[192:195]
    s_waitcnt lgkmcnt(7)
    v_mfma_f32_16x16x32_bf16 v[196:199], a[108:111], v[188:191], v[196:199]
    v_mfma_f32_16x16x32_bf16 v[200:203], v[188:191], a[172:175], v[200:203]
    v_mfma_f32_16x16x32_bf16 v[192:195], a[44:47], v[188:191], v[192:195]
    s_waitcnt lgkmcnt(6)
    v_mfma_f32_16x16x32_bf16 v[196:199], a[112:115], v[168:171], v[196:199]
    v_mfma_f32_16x16x32_bf16 v[200:203], v[168:171], a[176:179], v[200:203]
    v_mfma_f32_16x16x32_bf16 v[192:195], a[48:51], v[168:171], v[192:195]
    s_waitcnt lgkmcnt(5)
    v_mfma_f32_16x16x32_bf16 v[196:199], a[116:119], v[172:175], v[196:199]
    v_mfma_f32_16x16x32_bf16 v[200:203], v[172:175], a[180:183], v[200:203]
    v_mfma_f32_16x16x32_bf16 v[192:195], a[52:55], v[172:175], v[192:195]
    s_waitcnt lgkmcnt(4)
    v_mfma_f32_16x16x32_bf16 v[196:199], a[120:123], v[176:179], v[196:199]
    v_mfma_f32_16x16x32_bf16 v[200:203], v[176:179], a[184:187], v[200:203]
    v_mfma_f32_16x16x32_bf16 v[192:195], a[56:59], v[176:179], v[192:195]
    s_waitcnt lgkmcnt(3)
    v_mfma_f32_16x16x32_bf16 v[196:199], a[124:127], v[180:183], v[196:199]
    v_mfma_f32_16x16x32_bf16 v[200:203], v[180:183], a[188:191], v[200:203]
    v_mfma_f32_16x16x32_bf16 v[192:195], a[60:63], v[180:183], v[192:195]
    s_waitcnt lgkmcnt(0)
    s_nop 4
    v_pk_fma_f32 v[196:197], v[20:21], v[156:157], v[196:197] op_sel_hi:[1,0,1] neg_lo:[0,1,0] neg_hi:[0,1,0]
    v_pk_fma_f32 v[198:199], v[22:23], v[156:157], v[198:199] op_sel_hi:[1,0,1] neg_lo:[0,1,0] neg_hi:[0,1,0]
    v_pk_fma_f32 v[200:201], v[160:161], v[24:25], v[200:201] op_sel_hi:[1,0,1] neg_lo:[0,1,0] neg_hi:[0,1,0]
    v_pk_fma_f32 v[202:203], v[162:163], v[24:25], v[202:203] op_sel_hi:[1,0,1] neg_lo:[0,1,0] neg_hi:[0,1,0]
    v_pk_fma_f32 v[192:193], v[16:17], v[156:157], v[192:193] op_sel_hi:[1,0,1] neg_lo:[0,1,0] neg_hi:[0,1,0]
    v_pk_fma_f32 v[194:195], v[18:19], v[156:157], v[194:195] op_sel_hi:[1,0,1] neg_lo:[0,1,0] neg_hi:[0,1,0]
    v_pk_mul_f32 v[196:197], v[196:197], v[156:157] op_sel:[0,1] op_sel_hi:[1,1]
    v_pk_mul_f32 v[198:199], v[198:199], v[156:157] op_sel:[0,1] op_sel_hi:[1,1]
    v_pk_mul_f32 v[200:201], v[200:201], v[164:165]
    v_pk_mul_f32 v[202:203], v[202:203], v[166:167]
    s_cmp_lg_u32 s61, 0
    s_cbranch_scc1 LB_109
    v_cvt_pk_bf16_f32 v128, v196, v197
    v_cvt_pk_bf16_f32 v129, v198, v199
    v_cvt_pk_bf16_f32 v138, v200, v201
    v_cvt_pk_bf16_f32 v139, v202, v203
    s_branch LB_108
LB_109:
    s_cmp_lg_u32 s61, 1
    s_cbranch_scc1 LB_110
    v_mul_f32 v148, s90, v157
    v_cvt_pk_bf16_f32 v120, v192, v193
    v_cvt_pk_bf16_f32 v121, v194, v195
    v_cvt_pk_bf16_f32 v130, v196, v197
    v_cvt_pk_bf16_f32 v131, v198, v199
    v_cvt_pk_bf16_f32 v140, v200, v201
    v_cvt_pk_bf16_f32 v141, v202, v203
    s_branch LB_108
LB_110:
    s_cmp_lg_u32 s61, 2
    s_cbranch_scc1 LB_111
    v_mul_f32 v149, s90, v157
    v_cvt_pk_bf16_f32 v122, v192, v193
    v_cvt_pk_bf16_f32 v123, v194, v195
    v_cvt_pk_bf16_f32 v132, v196, v197
    v_cvt_pk_bf16_f32 v133, v198, v199
    v_cvt_pk_bf16_f32 v142, v200, v201
    v_cvt_pk_bf16_f32 v143, v202, v203
    s_branch LB_108
LB_111:
    s_cmp_lg_u32 s61, 3
    s_cbranch_scc1 LB_112
    v_mul_f32 v150, s90, v157
    v_cvt_pk_bf16_f32 v124, v192, v193
    v_cvt_pk_bf16_f32 v125, v194, v195
    v_cvt_pk_bf16_f32 v134, v196, v197
    v_cvt_pk_bf16_f32 v135, v198, v199
    v_cvt_pk_bf16_f32 v144, v200, v201
    v_cvt_pk_bf16_f32 v145, v202, v203
    s_branch LB_108
LB_112:
    v_mul_f32 v151, s90, v157
    v_cvt_pk_bf16_f32 v126, v192, v193
    v_cvt_pk_bf16_f32 v127, v194, v195
    v_cvt_pk_bf16_f32 v136, v196, v197
    v_cvt_pk_bf16_f32 v137, v198, v199
    v_cvt_pk_bf16_f32 v146, v200, v201
    v_cvt_pk_bf16_f32 v147, v202, v203
LB_108:
    s_cmp_lg_u32 s86, 0
    s_cbranch_scc1 L_QKV
L_NEXT:
    s_mov_b32 s53, 1
    s_mov_b32 s86, 0
    s_mov_b32 s85, 1
    s_mov_b32 s77, s51
    s_add_u32 s96, s96, 4096
    s_add_u32 s97, s97, 262144
    s_add_u32 s98, s98, 16384
    s_add_u32 s99, s99, 16384
    s_add_u32 s100, s100, 262144
    s_add_u32 s101, s101, 114688
    s_branch L_ATT
L_DONE:
    s_or_b32 s56, s2, s44
    s_cmp_lg_u32 s56, 0
    s_cbranch_scc1 L_FIN
    s_add_u32 s56, s87, 1
    v_mov_b32 v152, s56
    s_mov_b64 exec, 1
    buffer_store_dword v152, off, s[20:23], 0 offset:0 sc1
    s_mov_b64 exec, -1
L_FIN:
L_END:
    s_endpgm
L_AFF:
    s_bfe_u32 s56, s81, 327687
    s_bfe_u32 s57, s81, 131077
    s_add_u32 s8, s57, 1
    s_cmp_eq_u32 s56, s48
    s_cselect_b32 s8, s8, -1
    s_bfe_u32 s57, s81, 393217
    s_add_u32 s56, s56, 1
    s_cmp_ge_u32 s57, 57
    s_cselect_b32 s56, s56, -1
    s_cmp_eq_u32 s47, 0
    s_cselect_b32 s56, -1, s56
    s_cmp_eq_u32 s56, s48
    s_cselect_b32 s8, 0, s8
    s_bfe_u32 s56, s82, 327687
    s_bfe_u32 s57, s82, 131077
    s_add_u32 s9, s57, 1
    s_cmp_eq_u32 s56, s48
    s_cselect_b32 s9, s9, -1
    s_bfe_u32 s57, s82, 393217
    s_add_u32 s56, s56, 1
    s_cmp_ge_u32 s57, 57
    s_cselect_b32 s56, s56, -1
    s_cmp_eq_u32 s47, 0
    s_cselect_b32 s56, -1, s56
    s_cmp_eq_u32 s56, s48
    s_cselect_b32 s9, 0, s9
    s_lshl_b32 s56, 1, s8
    s_cmp_lt_i32 s8, 0
    s_cselect_b32 s75, 0, s56
    s_lshl_b32 s56, 1, s9
    s_cmp_lt_i32 s9, 0
    s_cselect_b32 s56, 0, s56
    s_or_b32 s75, s75, s56
    s_setpc_b64 s[0:1]
L_FIXA:
    s_mov_b32 s73, -1
    s_bfe_u32 s58, s81, 131077
    s_add_u32 s58, s58, 1
    s_and_b32 s58, s58, 3
    s_bfe_u32 s59, s82, 131077
    s_add_u32 s59, s59, 1
    s_and_b32 s59, s59, 3
    s_add_u32 s60, s59, 1
    s_and_b32 s60, s60, 3
    s_cmp_eq_u32 s59, s58
    s_cselect_b32 s59, s60, s59
    s_cmp_eq_u32 s44, s58
    s_cselect_b32 s61, s8, s9
    s_cselect_b32 s84, s81, s82
    s_cselect_b32 s56, 0, 2048
    s_cselect_b32 s59, s44, s59
    s_cmp_lg_u32 s44, s59
    s_cbranch_scc1 LZ_114
    s_cmp_lt_i32 s61, 0
    s_cbranch_scc1 LZ_114
    s_add_u32 s56, s56, 65536
    s_add_u32 s57, s56, 1024
    s_cmp_eq_u32 s61, 0
    s_cselect_b32 s73, s57, s56
    buffer_load_dwordx4 v[72:75], v3, s[20:23], s73 offen sc1
    s_bfe_u32 s57, s84, 262145
    v_lshrrev_b32 v80, 3, v0
    v_subrev_u32 v80, s50, v80
    v_and_b32 v80, 7, v80
    v_mul_u32_u24 v80, 10240, v80
    s_and_b32 s58, s57, 6
    v_and_b32 v81, 7, v0
    v_xor_b32 v81, s58, v81
    v_lshl_add_u32 v80, v81, 4, v80
    s_lshl_b32 s58, s61, 4
    s_add_u32 s58, s58, s57
    s_lshl_b32 s59, s58, 7
    v_add_u32 v80, s59, v80
    s_lshl_b32 s58, s58, 2
    s_add_u32 s58, s58, 156672
    v_mov_b32 v81, s58
    v_mov_b32 v76, 0
    v_mov_b32 v78, 0
LZ_114:
    s_setpc_b64 s[0:1]
L_OWN:
    s_mov_b32 s83, 0
    s_mov_b32 s84, s81
LW_115:
    s_bfe_u32 s56, s84, 458757
    s_cmp_lg_u32 s56, s55
    s_cbranch_scc1 LW_116
    s_mul_i32 s56, s53, 114688
    s_lshl_b32 s57, s83, 3
    s_add_u32 s57, s57, s45
    s_mul_i32 s57, s57, 7168
    s_add_u32 s56, s56, s57
    s_add_u32 s58, s56, 1179648
    v_min_u32 v231, 55, v0
    v_lshlrev_b32 v231, 7, v231
    buffer_load_dword v244, v231, s[20:23], s58 offen sc1
    s_bfe_u32 s62, s84, 262145
    v_cmp_eq_u32 s[60:61], s62, v1
    s_lshl_b32 s57, s44, 8
    s_add_u32 s57, s57, 159744
    v_lshlrev_b32 v194, 3, v2
    v_add_u32 v194, s57, v194
    v_and_b32 v224, 7, v0
    v_and_b32 v195, 1, v2
    v_lshlrev_b32 v195, 3, v195
    v_lshl_add_u32 v195, v224, 4, v195
    v_add_u32 v193, s57, v195
    s_mov_b64 exec, s[60:61]
    ds_write2_b64 v194, v[72:73], v[74:75] offset0:0 offset1:4
    ds_write2_b64 v194, v[76:77], v[78:79] offset0:8 offset1:12
    ds_write2_b64 v194, v[80:81], v[82:83] offset0:16 offset1:20
    ds_write2_b64 v194, v[84:85], v[86:87] offset0:24 offset1:28
    s_mov_b64 exec, -1
    ds_read2_b64 v[172:175], v193 offset0:0 offset1:16
    s_and_b32 s56, s84, 0xfffff000
    s_ashr_i32 s57, s56, 31
    s_not_b32 s57, s57
    s_or_b32 s57, s57, 0x80000000
    s_xor_b32 s56, s56, s57
    v_mov_b32 v192, s56
    v_cvt_pk_bf16_f32 v192, v192, v192
    v_and_b32 v192, 0xffff0000, v192
    v_mul_f32 v192, 0xbfb8aa3b, v192
    v_exp_f32 v192, v192
    v_mov_b32 v225, 0x3f80
    v_add_f32 v192, 1.0, v192
    v_rcp_f32 v192, v192
    v_mov_b32 v226, 0x3f800000
    v_cvt_pk_bf16_f32 v192, v192, v192
    v_and_b32 v192, 0xffff0000, v192
    v_cmp_eq_u32 vcc, 0, v224
    v_cmp_eq_u32 s[6:7], 1, v224
    s_nop 0
    v_cndmask_b32 v236, 0, v225, vcc
    v_cndmask_b32 v236, v236, v226, s[6:7]
    v_cmp_eq_u32 vcc, 2, v224
    v_cmp_eq_u32 s[6:7], 3, v224
    s_nop 0
    v_cndmask_b32 v237, 0, v225, vcc
    v_cndmask_b32 v237, v237, v226, s[6:7]
    v_cmp_eq_u32 vcc, 4, v224
    v_cmp_eq_u32 s[6:7], 5, v224
    s_nop 0
    v_cndmask_b32 v238, 0, v225, vcc
    v_cndmask_b32 v238, v238, v226, s[6:7]
    v_cmp_eq_u32 vcc, 6, v224
    v_cmp_eq_u32 s[6:7], 7, v224
    s_nop 0
    v_cndmask_b32 v239, 0, v225, vcc
    v_cndmask_b32 v239, v239, v226, s[6:7]
    s_lshl_b32 s56, s83, 11
    s_lshl_b32 s57, s45, 7
    s_add_u32 s56, s56, s57
    s_add_u32 s59, s56, 65536
    s_lshl_b32 s62, s62, 11
    s_add_u32 s62, s62, s91
    s_add_u32 s56, s58, 4096
    s_mov_b32 s63, 0x00ff00ff
    s_waitcnt lgkmcnt(0)
    s_cmp_lg_u32 s10, 1
    s_cbranch_scc1 L_OWNR
    s_mov_b32 s10, 2
    s_setpc_b64 s[0:1]
L_OWNR:
    s_waitcnt vmcnt(0)
    v_cmp_eq_u32 vcc, -1, v244
    s_cbranch_vccnz LP_118
LP_119:
    s_mov_b32 s80, 0x100000
LP_123:
    buffer_load_dwordx4 v[212:215], v3, s[20:23], s58 offen offset:0 sc1
    buffer_load_dwordx4 v[216:219], v3, s[20:23], s58 offen offset:1024 sc1
    buffer_load_dwordx4 v[220:223], v3, s[20:23], s58 offen offset:2048 sc1
    buffer_load_dwordx4 v[224:227], v3, s[20:23], s58 offen offset:3072 sc1
    buffer_load_dwordx4 v[232:235], v3, s[20:23], s56 offen offset:0 sc1
    buffer_load_dwordx4 v[244:247], v3, s[20:23], s56 offen offset:1024 sc1
    buffer_load_dwordx4 v[248:251], v3, s[20:23], s56 offen offset:2048 sc1
    s_waitcnt vmcnt(6)
    v_mfma_f32_16x16x32_bf16 v[152:155], v[236:239], v[212:215], 0
    s_waitcnt vmcnt(5)
    v_mfma_f32_16x16x32_bf16 v[152:155], v[236:239], v[216:219], v[152:155]
    s_waitcnt vmcnt(4)
    v_mfma_f32_16x16x32_bf16 v[152:155], v[236:239], v[220:223], v[152:155]
    s_waitcnt vmcnt(3)
    v_mfma_f32_16x16x32_bf16 v[152:155], v[236:239], v[224:227], v[152:155]
    v_lshlrev_b32 v216, 16, v172
    v_and_b32 v217, 0xffff0000, v172
    s_waitcnt vmcnt(2)
    v_mfma_f32_16x16x32_bf16 v[152:155], v[236:239], v[232:235], v[152:155]
    v_lshlrev_b32 v218, 16, v173
    v_and_b32 v219, 0xffff0000, v173
    s_waitcnt vmcnt(1)
    v_mfma_f32_16x16x32_bf16 v[152:155], v[236:239], v[244:247], v[152:155]
    v_lshlrev_b32 v220, 16, v174
    v_and_b32 v221, 0xffff0000, v174
    s_waitcnt vmcnt(0)
    v_mfma_f32_16x16x32_bf16 v[152:155], v[236:239], v[248:251], v[152:155]
    v_lshlrev_b32 v222, 16, v175
    v_and_b32 v223, 0xffff0000, v175
    s_nop 5
    v_add_f32_dpp v152, v152, v152 row_ror:8 row_mask:0xf bank_mask:0xf
    v_add_f32_dpp v153, v153, v153 row_ror:8 row_mask:0xf bank_mask:0xf
    v_add_f32_dpp v154, v154, v154 row_ror:8 row_mask:0xf bank_mask:0xf
    v_add_f32_dpp v155, v155, v155 row_ror:8 row_mask:0xf bank_mask:0xf
    v_cmp_u_f32 vcc, v152, v152
    s_cbranch_vccnz LP_124
LP_125:
    v_cvt_pk_bf16_f32 v212, v152, v153
    v_cvt_pk_bf16_f32 v213, v154, v155
    v_lshlrev_b32 v152, 16, v212
    v_and_b32 v153, 0xffff0000, v212
    v_lshlrev_b32 v154, 16, v213
    v_and_b32 v155, 0xffff0000, v213
    v_pk_mul_f32 v[152:153], v[152:153], v[192:193] op_sel_hi:[1,0]
    v_pk_mul_f32 v[154:155], v[154:155], v[192:193] op_sel_hi:[1,0]
    v_cvt_pk_bf16_f32 v212, v152, v153
    v_cvt_pk_bf16_f32 v213, v154, v155
    v_lshlrev_b32 v152, 16, v212
    v_and_b32 v153, 0xffff0000, v212
    v_lshlrev_b32 v154, 16, v213
    v_and_b32 v155, 0xffff0000, v213
    v_pk_add_f32 v[152:153], v[152:153], v[220:221]
    v_pk_add_f32 v[154:155], v[154:155], v[222:223]
    v_cvt_pk_bf16_f32 v212, v152, v153
    v_cvt_pk_bf16_f32 v213, v154, v155
    v_lshlrev_b32 v152, 16, v212
    v_and_b32 v153, 0xffff0000, v212
    v_lshlrev_b32 v154, 16, v213
    v_and_b32 v155, 0xffff0000, v213
    v_pk_add_f32 v[152:153], v[152:153], v[216:217]
    v_pk_add_f32 v[154:155], v[154:155], v[218:219]
    s_cmp_lg_u32 s53, 0
    v_cvt_pk_bf16_f32 v212, v152, v153
    v_cvt_pk_bf16_f32 v213, v154, v155
    s_mov_b32 exec_lo, s63
    s_mov_b32 exec_hi, 0
    s_cbranch_scc1 LW_126
    s_cmp_eq_u32 s51, 0
    s_cbranch_scc1 LS_127
    buffer_store_dwordx2 v[212:213], v195, s[20:23], s59 offen
LS_128:
    buffer_store_dwordx2 v[212:213], v195, s[20:23], s59 offen offset:1024 sc1
    ds_write_b64 v193, v[212:213]
    s_mov_b64 exec, s[60:61]
    ds_read2_b64 v[216:219], v194 offset0:0 offset1:4
    ds_read2_b64 v[220:223], v194 offset0:8 offset1:12
    s_waitcnt lgkmcnt(0)
    v_lshlrev_b32 v56, 16, v216
    v_and_b32 v57, 0xffff0000, v216
    v_lshlrev_b32 v58, 16, v217
    v_and_b32 v59, 0xffff0000, v217
    v_lshlrev_b32 v60, 16, v218
    v_and_b32 v61, 0xffff0000, v218
    v_lshlrev_b32 v62, 16, v219
    v_and_b32 v63, 0xffff0000, v219
    v_lshlrev_b32 v64, 16, v220
    v_and_b32 v65, 0xffff0000, v220
    v_lshlrev_b32 v66, 16, v221
    v_and_b32 v67, 0xffff0000, v221
    v_lshlrev_b32 v68, 16, v222
    v_and_b32 v69, 0xffff0000, v222
    v_lshlrev_b32 v70, 16, v223
    v_and_b32 v71, 0xffff0000, v223
    s_mov_b64 exec, -1
    s_branch LW_116
LW_126:
    buffer_store_dwordx2 v[212:213], v195, s[24:27], s62 offen
    s_mov_b64 exec, -1
LW_116:
    s_mov_b32 s84, s82
    s_add_u32 s83, s83, 1
    s_cmp_lt_u32 s83, 2
    s_cbranch_scc1 LW_115
    s_setpc_b64 s[0:1]
L_SRETRY:
    s_mov_b32 s80, 0x100000
L_SLOOP:
    buffer_load_dwordx4 v[108:111], v96, s[20:23], s62 offen sc1
    s_waitcnt vmcnt(0)
    v_cmp_ne_u32 vcc, s49, v110
    s_cbranch_vccz L_SOK
    s_sub_u32 s80, s80, 1
    s_cbranch_scc0 L_SLOOP
    s_branch L_SOK
L_XRETRY:
    s_mov_b32 s80, 0x100000
L_XLOOP:
    buffer_load_dword v113, v112, s[20:23], s63 offen sc1
    s_waitcnt vmcnt(0)
    v_subrev_u32 v114, s49, v113
    v_cmp_le_u32 vcc, 16, v114
    s_cbranch_vccz L_XOK
    s_sub_u32 s80, s80, 1
    s_cbranch_scc0 L_XLOOP
    s_branch L_XOK
LS_17:
    buffer_store_dword v248, off, s[20:23], s96 sc1
    s_branch LS_18
LS_19:
    buffer_store_dword v248, off, s[20:23], s96 sc1
    s_branch LS_20
LP_22:
    s_mov_b32 s80, 0x80000
    buffer_load_dword v249, v30, s[20:23], s59 offen sc1
    s_sleep 1
    buffer_load_dword v250, v30, s[20:23], s59 offen sc1
    s_sleep 1
LP_21:
    buffer_load_dword v251, v30, s[20:23], s59 offen sc1
    s_waitcnt vmcnt(2)
    v_cmp_ne_u32 vcc, s49, v249
    s_cbranch_vccz LP_23
    buffer_load_dword v249, v30, s[20:23], s59 offen sc1
    s_waitcnt vmcnt(2)
    v_cmp_ne_u32 vcc, s49, v250
    s_cbranch_vccz LP_23
    buffer_load_dword v250, v30, s[20:23], s59 offen sc1
    s_waitcnt vmcnt(2)
    v_cmp_ne_u32 vcc, s49, v251
    s_cbranch_vccz LP_23
    s_sub_u32 s80, s80, 1
    s_cbranch_scc0 LP_21
    s_branch LP_23
LS_27:
    buffer_store_dwordx4 v[152:155], v248, s[20:23], s60 offen sc1
    s_branch LS_28
LS_30:
    buffer_store_dwordx4 v[216:219], v4, s[24:27], s91 offen sc1
    buffer_store_dwordx4 v[220:223], v4, s[24:27], s56 offen sc1
    s_branch LS_31
LS_34:
    buffer_store_dword v186, off, s[20:23], s59 sc1
    s_branch LS_35
LP_37:
    s_mov_b32 s80, 0x80000
    buffer_load_dwordx4 v[120:123], v3, s[20:23], s97 offen sc1
    buffer_load_dwordx4 v[124:127], v3, s[20:23], s97 offen offset:1024 sc1
    s_sleep 1
    buffer_load_dwordx4 v[128:131], v3, s[20:23], s97 offen sc1
    buffer_load_dwordx4 v[132:135], v3, s[20:23], s97 offen offset:1024 sc1
    s_sleep 1
LP_36:
    buffer_load_dwordx4 v[136:139], v3, s[20:23], s97 offen sc1
    buffer_load_dwordx4 v[140:143], v3, s[20:23], s97 offen offset:1024 sc1
    s_waitcnt vmcnt(4)
    v_cmp_ne_u32 vcc, s49, v123
    v_cmp_ne_u32 s[6:7], s49, v127
    s_nop 0
    s_or_b64 vcc, vcc, s[6:7]
    s_cbranch_vccz LP_39
    buffer_load_dwordx4 v[120:123], v3, s[20:23], s97 offen sc1
    buffer_load_dwordx4 v[124:127], v3, s[20:23], s97 offen offset:1024 sc1
    s_waitcnt vmcnt(4)
    v_cmp_ne_u32 vcc, s49, v131
    v_cmp_ne_u32 s[6:7], s49, v135
    s_nop 0
    s_or_b64 vcc, vcc, s[6:7]
    s_cbranch_vccz LP_40
    buffer_load_dwordx4 v[128:131], v3, s[20:23], s97 offen sc1
    buffer_load_dwordx4 v[132:135], v3, s[20:23], s97 offen offset:1024 sc1
    s_waitcnt vmcnt(4)
    v_cmp_ne_u32 vcc, s49, v139
    v_cmp_ne_u32 s[6:7], s49, v143
    s_nop 0
    s_or_b64 vcc, vcc, s[6:7]
    s_cbranch_vccz LP_41
    s_sub_u32 s80, s80, 1
    s_cbranch_scc0 LP_36
LP_39:
    v_mov_b32 v168, v120
    v_mov_b32 v169, v121
    v_mov_b32 v170, v122
    v_mov_b32 v172, v124
    v_mov_b32 v173, v125
    v_mov_b32 v174, v126
    s_branch LP_38
LP_40:
    v_mov_b32 v168, v128
    v_mov_b32 v169, v129
    v_mov_b32 v170, v130
    v_mov_b32 v172, v132
    v_mov_b32 v173, v133
    v_mov_b32 v174, v134
    s_branch LP_38
LP_41:
    v_mov_b32 v168, v136
    v_mov_b32 v169, v137
    v_mov_b32 v170, v138
    v_mov_b32 v172, v140
    v_mov_b32 v173, v141
    v_mov_b32 v174, v142
    s_branch LP_38
LP_57:
    s_mov_b32 s80, 0x80000
    buffer_load_dwordx4 v[120:123], v3, s[20:23], s99 offen sc1
    buffer_load_dwordx4 v[124:127], v3, s[20:23], s99 offen offset:1024 sc1
    s_sleep 1
    buffer_load_dwordx4 v[128:131], v3, s[20:23], s99 offen sc1
    buffer_load_dwordx4 v[132:135], v3, s[20:23], s99 offen offset:1024 sc1
    s_sleep 1
LP_56:
    buffer_load_dwordx4 v[136:139], v3, s[20:23], s99 offen sc1
    buffer_load_dwordx4 v[140:143], v3, s[20:23], s99 offen offset:1024 sc1
    s_waitcnt vmcnt(4)
    v_cmp_ne_u32 vcc, s49, v122
    v_cmp_ne_u32 s[6:7], s49, v126
    s_nop 0
    s_or_b64 vcc, vcc, s[6:7]
    s_cbranch_vccz LP_59
    buffer_load_dwordx4 v[120:123], v3, s[20:23], s99 offen sc1
    buffer_load_dwordx4 v[124:127], v3, s[20:23], s99 offen offset:1024 sc1
    s_waitcnt vmcnt(4)
    v_cmp_ne_u32 vcc, s49, v130
    v_cmp_ne_u32 s[6:7], s49, v134
    s_nop 0
    s_or_b64 vcc, vcc, s[6:7]
    s_cbranch_vccz LP_60
    buffer_load_dwordx4 v[128:131], v3, s[20:23], s99 offen sc1
    buffer_load_dwordx4 v[132:135], v3, s[20:23], s99 offen offset:1024 sc1
    s_waitcnt vmcnt(4)
    v_cmp_ne_u32 vcc, s49, v138
    v_cmp_ne_u32 s[6:7], s49, v142
    s_nop 0
    s_or_b64 vcc, vcc, s[6:7]
    s_cbranch_vccz LP_61
    s_sub_u32 s80, s80, 1
    s_cbranch_scc0 LP_56
LP_59:
    v_mov_b32 v216, v120
    v_mov_b32 v217, v121
    v_mov_b32 v220, v124
    v_mov_b32 v221, v125
    s_branch LP_58
LP_60:
    v_mov_b32 v216, v128
    v_mov_b32 v217, v129
    v_mov_b32 v220, v132
    v_mov_b32 v221, v133
    s_branch LP_58
LP_61:
    v_mov_b32 v216, v136
    v_mov_b32 v217, v137
    v_mov_b32 v220, v140
    v_mov_b32 v221, v141
    s_branch LP_58
LR_67:
    s_mov_b32 s80, 0x100000
LR_66:
    buffer_load_dwordx4 v[152:155], v240, s[20:23], s62 offen offset:0 sc1
    buffer_load_dwordx4 v[156:159], v240, s[20:23], s62 offen offset:64 sc1
    buffer_load_dwordx4 v[160:163], v240, s[20:23], s62 offen offset:128 sc1
    buffer_load_dwordx4 v[164:167], v240, s[20:23], s62 offen offset:192 sc1
    s_waitcnt vmcnt(0)
    v_max3_u32 v246, v152, v153, v154
    v_max3_u32 v246, v246, v155, v156
    v_max3_u32 v246, v246, v157, v158
    v_max3_u32 v246, v246, v159, v160
    v_max3_u32 v246, v246, v161, v162
    v_max3_u32 v246, v246, v163, v164
    v_max3_u32 v246, v246, v165, v166
    v_max_u32 v246, v246, v167
    v_cmp_eq_u32 vcc, -1, v246
    s_cbranch_vccz LR_65
    s_sub_u32 s80, s80, 1
    s_cbranch_scc0 LR_66
    s_branch LR_65
LP_71:
    s_mov_b32 s80, 0x80000
    buffer_load_dword v242, v30, s[20:23], s56 offen sc1
    s_sleep 1
LP_70:
    buffer_load_dword v243, v30, s[20:23], s56 offen sc1
    s_waitcnt vmcnt(1)
    v_cmp_ne_u32 vcc, s49, v242
    s_cbranch_vccz LP_72
    buffer_load_dword v242, v30, s[20:23], s56 offen sc1
    s_waitcnt vmcnt(1)
    v_cmp_ne_u32 vcc, s49, v243
    s_cbranch_vccz LP_72
    s_sub_u32 s80, s80, 1
    s_cbranch_scc0 LP_70
    s_branch LP_72
LW_75:
    s_cmp_eq_u32 s61, 2
    s_cbranch_scc0 LW_76
    s_waitcnt vmcnt(7) lgkmcnt(0)
    s_branch LW_77
LW_76:
    s_waitcnt vmcnt(4) lgkmcnt(0)
    s_branch LW_77
LW_78:
    s_cmp_eq_u32 s61, 2
    s_cbranch_scc0 LW_79
    s_waitcnt vmcnt(9) lgkmcnt(0)
    s_branch LW_80
LW_79:
    s_waitcnt vmcnt(6) lgkmcnt(0)
    s_branch LW_80
LH_83:
    s_mov_b32 s80, 0x100000
LH_85:
    s_sleep 2
    buffer_load_dword v241, v240, s[20:23], s62 offen sc1
    s_waitcnt vmcnt(0)
    v_cmp_ne_u32 vcc, s49, v241
    s_cbranch_vccz LH_84
    s_sub_u32 s80, s80, 1
    s_cbranch_scc0 LH_85
    s_branch LH_84
LP_97:
    s_sleep 6
    s_sub_u32 s80, s80, 1
    s_cbranch_scc0 LP_96
    s_branch LP_98
LP_103:
    s_mov_b32 s80, 0x80000
    buffer_load_dwordx4 v[208:211], v3, s[20:23], s73 offen sc1
    s_sleep 1
    buffer_load_dwordx4 v[212:215], v3, s[20:23], s73 offen sc1
    s_sleep 1
LP_102:
    buffer_load_dwordx4 v[216:219], v3, s[20:23], s73 offen sc1
    s_waitcnt vmcnt(2)
    v_max3_u32 v77, v208, v209, v210
    v_max_u32 v77, v77, v211
    v_cmp_eq_u32 vcc, -1, v77
    s_cbranch_vccz LP_105
    buffer_load_dwordx4 v[208:211], v3, s[20:23], s73 offen sc1
    s_waitcnt vmcnt(2)
    v_max3_u32 v77, v212, v213, v214
    v_max_u32 v77, v77, v215
    v_cmp_eq_u32 vcc, -1, v77
    s_cbranch_vccz LP_106
    buffer_load_dwordx4 v[212:215], v3, s[20:23], s73 offen sc1
    s_waitcnt vmcnt(2)
    v_max3_u32 v77, v216, v217, v218
    v_max_u32 v77, v77, v219
    v_cmp_eq_u32 vcc, -1, v77
    s_cbranch_vccz LP_107
    s_sub_u32 s80, s80, 1
    s_cbranch_scc0 LP_102
LP_105:
    v_mov_b32 v72, v208
    v_mov_b32 v73, v209
    v_mov_b32 v74, v210
    v_mov_b32 v75, v211
    s_branch LP_104
LP_106:
    v_mov_b32 v72, v212
    v_mov_b32 v73, v213
    v_mov_b32 v74, v214
    v_mov_b32 v75, v215
    s_branch LP_104
LP_107:
    v_mov_b32 v72, v216
    v_mov_b32 v73, v217
    v_mov_b32 v74, v218
    v_mov_b32 v75, v219
    s_branch LP_104
LP_118:
    s_mov_b32 s80, 0x80000
    buffer_load_dword v245, v231, s[20:23], s58 offen sc1
    s_sleep 1
    buffer_load_dword v246, v231, s[20:23], s58 offen sc1
    s_sleep 1
LP_117:
    buffer_load_dword v247, v231, s[20:23], s58 offen sc1
    s_waitcnt vmcnt(2)
    v_cmp_eq_u32 vcc, -1, v245
    s_cbranch_vccz LP_119
    buffer_load_dword v245, v231, s[20:23], s58 offen sc1
    s_waitcnt vmcnt(2)
    v_cmp_eq_u32 vcc, -1, v246
    s_cbranch_vccz LP_119
    buffer_load_dword v246, v231, s[20:23], s58 offen sc1
    s_waitcnt vmcnt(2)
    v_cmp_eq_u32 vcc, -1, v247
    s_cbranch_vccz LP_119
    s_sub_u32 s80, s80, 1
    s_cbranch_scc0 LP_117
    s_branch LP_119
LP_124:
    s_sub_u32 s80, s80, 1
    s_cbranch_scc0 LP_123
    s_branch LP_125
LS_127:
    buffer_store_dwordx2 v[212:213], v195, s[20:23], s59 offen sc1
    s_branch LS_128
L_CODE_END:
.section .rodata,"a"
.p2align 6
.amdhsa_kernel interleave_layers__sliding_local_dilated__moe_arch_mod__prompt_kernel
  .amdhsa_next_free_vgpr 512
  .amdhsa_next_free_sgpr 102
  .amdhsa_accum_offset 256
  .amdhsa_group_segment_fixed_size 0
  .amdhsa_kernarg_size 88
  .amdhsa_user_sgpr_count 2
  .amdhsa_user_sgpr_kernarg_segment_ptr 1
  .amdhsa_system_sgpr_workgroup_id_x 1
.end_amdhsa_kernel
```
